```python
import torch

def _softmax(x, axis=-1):
    return torch.softmax(x, dim=axis)
def _gelu(x):
    return torch.nn.functional.gelu(x, approximate="tanh")
def _silu(x):
    return torch.nn.functional.silu(x)
def _sigmoid(x):
    return torch.sigmoid(x)
def _layernorm(x, axis=-1, eps=1e-5):
    m = x.mean(dim=axis, keepdim=True)
    v = x.var(dim=axis, keepdim=True, unbiased=False)
    return (x - m) / torch.sqrt(v + eps)
def _scatter_add(tgt, idx, src, axis=0):
    return tgt.clone().index_add_(axis, idx, src)
def _segment_sum(src, seg, n):
    out = torch.zeros((n,) + src.shape[1:], dtype=src.dtype)
    return out.index_add_(0, seg, src)
def _pad(x, pw):
    flat = tuple(v for pair in reversed(pw) for v in pair)
    return torch.nn.functional.pad(x, flat)

kernel_name = 'standalone__batchnorm__prompt'

def setup_inputs():

    _w = (lambda a: (lambda t: t.to(torch.bfloat16) if t.is_floating_point() else t)(torch.as_tensor(a)))
    B, S, C = 1, 2048, 1024
    K = 3
    return {
        "x": _w((lambda *s: torch.randn(*s, dtype=torch.bfloat16) * 0.05)(B, S, C)),
        "w": _w((lambda *s: torch.randn(*s, dtype=torch.bfloat16) * 0.05)(K, C, C) * (1.0 / (K * C) ** 0.5)),
        "mean": _w((lambda *s: torch.randn(*s, dtype=torch.bfloat16) * 0.05)(C) * 0.1),
        "var": _w(torch.abs((lambda *s: torch.randn(*s, dtype=torch.bfloat16) * 0.05)(C)) + 0.5),
        "g": _w((lambda *s: torch.randn(*s, dtype=torch.bfloat16) * 0.05)(C) + 1.0),
        "b": _w((lambda *s: torch.randn(*s, dtype=torch.bfloat16) * 0.05)(C) * 0.1),
    }

def reference(x, w, mean, var, g, b):
    K = 3
    P = K // 2
    S = x.shape[1]
    xp = _pad(x, ((0, 0), (P, P), (0, 0)))
    y = sum(torch.einsum('bsc,cd->bsd', xp[:, k:k + S, :], w[k]) for k in range(K))
    inv_std = 1.0 / torch.sqrt(var + 1e-5)
    y = (y - mean) * (g * inv_std) + b
    return _silu(y)
```

```asm
; @launch grid=(256,1,1) block=(512,1,1) lds=124160
.amdgcn_target "amdgcn-amd-amdhsa--gfx950"
.text
.globl standalone__batchnorm__prompt_kernel
.p2align 12
.p2align 8
.type standalone__batchnorm__prompt_kernel,@function
standalone__batchnorm__prompt_kernel:
    s_load_dwordx16 s[80:95], s[0:1], 0
    s_cmp_ge_u32 s2, 256
    s_cbranch_scc1 L_end
    v_lshrrev_b32 v1, 6, v0
    v_and_b32 v0, 63, v0
    s_and_b32 s3, s2, 7
    s_lshl_b32 s3, s3, 2
    s_lshr_b32 s3, 0x75643120, s3
    s_and_b32 s20, s3, 1
    s_bfe_u32 s3, s3, 0x20001
    s_lshr_b32 s21, s2, 3
    v_readfirstlane_b32 s25, v1
    s_mov_b32 s6, 1
    s_cmp_eq_u32 s25, 3
    s_cbranch_scc0 L_ncp
    s_getpc_b64 s[8:9]
L_pc:
    s_sub_u32 s8, s8, L_pc-standalone__batchnorm__prompt_kernel
    s_subb_u32 s9, s9, 0
    s_lshl_b32 s10, s21, 9
    v_lshl_add_u32 v1, v0, 7, s10
    v_min_u32 v1, L_end-standalone__batchnorm__prompt_kernel, v1
    s_mov_b64 exec, 15
    global_load_dword v1, v1, s[8:9]
    s_mov_b64 exec, -1
L_ncp:
    s_cmp_eq_u32 s25, 1
    s_cbranch_scc1 L_t1
    s_cmp_eq_u32 s25, 2
    s_cbranch_scc1 L_t2
    s_cmp_lt_u32 s25, 4
    s_cbranch_scc1 L_cons
    s_and_b32 s23, s21, 7
    s_lshl3_add_u32 s26, s20, s23
    s_lshl_b32 s22, s26, 7
    s_lshr_b32 s23, s21, 3
    s_lshl2_add_u32 s27, s3, s23
    s_lshl_b32 s24, s27, 7
    s_and_b32 s4, s26, 1
    s_setprio 1
    s_and_b32 s23, s25, 3
    v_lshrrev_b32 v3, 3, v0
    v_and_b32 v4, 7, v0
    v_lshrrev_b32 v5, 4, v0
    s_lshl_b32 s28, s23, 5
    s_add_u32 s28, s28, s22
    v_lshl_add_u32 v6, v3, 2, s28
    v_lshlrev_b32 v6, 11, v6
    s_and_b32 s38, s23, 1
    s_lshl_b32 s38, s38, 2
    v_add_u32 v7, s38, v5
    v_xor_b32 v7, v7, v4
    v_lshl_add_u32 v10, v7, 4, v6
    s_add_u32 s39, s26, s27
    s_and_b32 s39, s39, 15
    s_and_b32 s37, s27, 7
    s_cmp_eq_u32 s37, 3
    s_cselect_b32 s39, 16, s39
    s_min_u32 s48, s39, 16
    s_lshl_b32 s48, s48, 2
    s_mov_b32 s40, 0x10
    s_mov_b32 s41, 0x0
    s_lshr_b64 s[40:41], s[40:41], s48
    s_and_b32 s32, s40, 15
    s_lshl_b32 s33, s32, 17
    s_lshl_b32 s32, s32, 7
    s_lshl_b32 s29, s23, 10
    s_mov_b32 m0, s29
    s_mov_b32 s10, 0x400000
    s_mov_b32 s11, 0x20000
    v_add_u32 v13, 6144, v10
    s_lshl_b32 s28, s23, 3
    s_lshl_b32 s30, s4, 5
    s_add_u32 s28, s28, s30
    v_add_u32 v6, s28, v3
    v_lshlrev_b32 v6, 11, v6
    v_add_u32 v6, s24, v6
    v_and_b32 v7, 1, v5
    v_lshlrev_b32 v7, 1, v7
    v_xor_b32 v7, s38, v7
    v_xor_b32 v7, v7, v4
    v_lshl_add_u32 v16, v7, 4, v6
    v_cmp_gt_u32 vcc, 8, v0
    s_mov_b32 s30, 4096
    s_add_u32 s28, s22, 128
    s_lshl_b32 s28, s28, 11
    s_sub_u32 s37, s22, 1
    s_lshl_b32 s37, s37, 11
    s_cmp_eq_u32 s22, 0
    s_cselect_b32 s37, 0x80000000, s37
    v_lshl_add_u32 v8, v4, 4, s28
    v_xor_b32 v7, 7, v4
    v_lshl_add_u32 v9, v7, 4, s37
    v_cndmask_b32 v14, v9, v8, vcc
    s_add_u32 s28, s29, 49920
    s_mov_b32 s14, 0x600000
    s_mov_b32 s15, 0x20000
    s_waitcnt lgkmcnt(0)
    s_mov_b32 s8, s80
    s_and_b32 s9, s81, 0xffff
    buffer_load_dwordx4 v10, s[8:11], s32 offen lds
    s_add_u32 m0, s29, 4352
    v_add_u32 v11, 2048, v10
    buffer_load_dwordx4 v13, s[8:11], s32 offen lds
    s_add_u32 m0, s29, 8448
    v_add_u32 v12, 4096, v10
    buffer_load_dwordx4 v11, s[8:11], s32 offen lds
    s_add_u32 m0, s29, 12544
    s_mov_b32 s12, s82
    buffer_load_dwordx4 v12, s[8:11], s32 offen lds
    s_cmp_lg_u32 s23, 0
    s_cbranch_scc1 L_nh1
    s_mov_b32 m0, s30
    s_mov_b64 exec, 0xffff
    buffer_load_dwordx4 v14, s[8:11], s32 offen lds
    s_mov_b64 exec, -1
L_nh1:
    s_add_u32 m0, s28, 0
    s_and_b32 s13, s83, 0xffff
    buffer_load_dwordx4 v16, s[12:15], s33 offen lds
    s_add_u32 m0, s28, 8192
    v_add_u32 v17, 2097152, v16
    buffer_load_dwordx4 v17, s[12:15], s33 offen lds
    s_add_u32 m0, s28, 16384
    v_add_u32 v18, 4194304, v16
    buffer_load_dwordx4 v18, s[12:15], s33 offen lds
    s_add_u32 m0, s28, 4096
    v_xor_b32 v19, 65536, v16
    buffer_load_dwordx4 v19, s[12:15], s33 offen lds
    s_add_u32 m0, s28, 12288
    v_xor_b32 v20, 65536, v17
    buffer_load_dwordx4 v20, s[12:15], s33 offen lds
    s_add_u32 m0, s28, 20480
    v_xor_b32 v21, 65536, v18
    buffer_load_dwordx4 v21, s[12:15], s33 offen lds
    s_cmp_eq_u32 s23, 1
    s_cselect_b64 s[16:17], s[86:87], s[84:85]
    s_cmp_eq_u32 s23, 2
    s_cselect_b64 s[16:17], s[88:89], s[16:17]
    s_cmp_eq_u32 s23, 3
    s_cselect_b64 s[16:17], s[90:91], s[16:17]
    s_and_b32 s17, s17, 0xffff
    s_mov_b32 s18, 2048
    s_mov_b32 s19, 0x20000
    v_lshlrev_b32 v6, 4, v0
    s_lshl_b32 s37, s23, 7
    s_add_u32 m0, s37, 123648
    s_mov_b64 exec, 0xff
    buffer_load_dwordx4 v6, s[16:19], s24 offen lds
    s_mov_b64 exec, -1
    s_lshl2_add_u32 s38, s21, s23
    s_bitcmp1_b32 s3, 0
    s_cbranch_scc1 L_odd0
    s_lshr_b32 s37, s38, 1
    s_lshl_b32 s37, s37, 11
    s_and_b32 s38, s38, 1
    s_lshl_b32 s38, s38, 6
    s_add_u32 s37, s37, s38
    s_lshl_b32 s38, s3, 9
    s_add_u32 s37, s37, s38
    s_add_u32 s37, s37, 384
    s_add_u32 s50, s82, s37
    s_addc_u32 s51, s83, 0
    s_add_u32 s52, s50, 0x200000
    s_addc_u32 s53, s51, 0
    s_add_u32 s54, s50, 0x400000
    s_addc_u32 s55, s51, 0
    s_mov_b32 s34, 131072
    s_load_dword s31, s[50:51], s34
    s_load_dword s31, s[52:53], s34
    s_load_dword s31, s[54:55], s34
    s_mov_b32 s34, 262144
    s_load_dword s31, s[50:51], s34
    s_load_dword s31, s[52:53], s34
    s_load_dword s31, s[54:55], s34
    s_mov_b32 s35, 2
    s_branch L_pf0
L_odd0:
    s_lshl_b32 s37, s38, 11
    s_lshl_b32 s38, s20, 6
    s_add_u32 s37, s37, s38
    s_add_u32 s50, s80, s37
    s_addc_u32 s51, s81, 0
    s_mov_b64 s[52:53], s[50:51]
    s_mov_b64 s[54:55], s[50:51]
    s_lshr_b32 s49, s3, 1
    s_lshl_b32 s49, s49, 3
    s_add_u32 s49, s49, 13
    s_add_u32 s34, s49, 1
    s_and_b32 s34, s34, 15
    s_lshl_b32 s34, s34, 18
    s_load_dword s31, s[50:51], s34 offset:128
    s_add_u32 s34, s49, 2
    s_and_b32 s34, s34, 15
    s_lshl_b32 s34, s34, 18
    s_load_dword s31, s[50:51], s34 offset:256
    s_mov_b32 s35, 2
L_pf0:
    s_mov_b32 s40, 0x765b3210
    s_mov_b32 s41, 0xfedc4a98
    s_cmp_eq_u32 s39, 1
    s_cselect_b32 s40, 0x765b3201, s40
    s_cmp_eq_u32 s39, 2
    s_cselect_b32 s40, 0x765b3120, s40
    s_cmp_eq_u32 s39, 3
    s_cselect_b32 s40, 0x765b2310, s40
    s_cmp_eq_u32 s39, 4
    s_cselect_b32 s40, 0x7653b210, s40
    s_cmp_eq_u32 s39, 5
    s_cselect_b32 s40, 0x76b53210, s40
    s_cmp_eq_u32 s39, 6
    s_cselect_b32 s40, 0x756b3210, s40
    s_cmp_eq_u32 s39, 7
    s_cselect_b32 s40, 0x675b3210, s40
    s_cmp_eq_u32 s39, 8
    s_cselect_b32 s40, 0x865b3210, s40
    s_cselect_b32 s41, 0xfedc4a97, s41
    s_cmp_eq_u32 s39, 9
    s_cselect_b32 s41, 0xfedc4a89, s41
    s_cmp_eq_u32 s39, 10
    s_cselect_b32 s41, 0xfedc49a8, s41
    s_cmp_eq_u32 s39, 11
    s_cselect_b32 s41, 0xfedca498, s41
    s_cmp_eq_u32 s39, 12
    s_cselect_b32 s41, 0xfed4ca98, s41
    s_cmp_eq_u32 s39, 13
    s_cselect_b32 s41, 0xfecd4a98, s41
    s_cmp_eq_u32 s39, 14
    s_cselect_b32 s41, 0xfdec4a98, s41
    s_cmp_eq_u32 s39, 15
    s_cselect_b32 s41, 0xefdc4a98, s41
    s_lshr_b64 s[40:41], s[40:41], 4
    s_and_b32 s32, s40, 15
    s_lshl_b32 s33, s32, 17
    s_lshl_b32 s32, s32, 7
    s_add_u32 s29, s29, 16640
    s_add_u32 s30, s30, 16640
    s_add_u32 s28, s28, 24576
    s_add_u32 m0, s29, 0
    s_nop 0
    buffer_load_dwordx4 v10, s[8:11], s32 offen lds
    s_add_u32 m0, s29, 4352
    s_nop 0
    buffer_load_dwordx4 v13, s[8:11], s32 offen lds
    s_add_u32 m0, s29, 8448
    s_nop 0
    buffer_load_dwordx4 v11, s[8:11], s32 offen lds
    s_add_u32 m0, s29, 12544
    s_nop 0
    buffer_load_dwordx4 v12, s[8:11], s32 offen lds
    s_cmp_lg_u32 s23, 0
    s_cbranch_scc1 L_nh2
    s_mov_b32 m0, s30
    s_mov_b64 exec, 0xffff
    buffer_load_dwordx4 v14, s[8:11], s32 offen lds
    s_mov_b64 exec, -1
L_nh2:
    s_waitcnt vmcnt(9)
    s_cmp_eq_u32 s23, 0
    s_cbranch_scc1 L_wh3
    s_waitcnt vmcnt(8)
L_wh3:
    s_barrier
    s_add_u32 m0, s28, 0
    s_nop 0
    buffer_load_dwordx4 v16, s[12:15], s33 offen lds
    s_add_u32 m0, s28, 8192
    s_nop 0
    buffer_load_dwordx4 v17, s[12:15], s33 offen lds
    s_add_u32 m0, s28, 16384
    s_nop 0
    buffer_load_dwordx4 v18, s[12:15], s33 offen lds
    s_waitcnt vmcnt(8)
    s_cmp_eq_u32 s23, 0
    s_cbranch_scc1 L_wh4
    s_waitcnt vmcnt(7)
L_wh4:
    s_barrier
    s_add_u32 m0, s28, 4096
    s_nop 0
    buffer_load_dwordx4 v19, s[12:15], s33 offen lds
    s_add_u32 m0, s28, 12288
    s_nop 0
    buffer_load_dwordx4 v20, s[12:15], s33 offen lds
    s_add_u32 m0, s28, 20480
    s_nop 0
    buffer_load_dwordx4 v21, s[12:15], s33 offen lds
    s_lshr_b64 s[40:41], s[40:41], 4
    s_and_b32 s32, s40, 15
    s_lshl_b32 s33, s32, 17
    s_lshl_b32 s32, s32, 7
    s_add_u32 s29, s29, 16640
    s_add_u32 s30, s30, 16640
    s_add_u32 s28, s28, 24576
    s_add_u32 m0, s29, 0
    s_nop 0
    buffer_load_dwordx4 v10, s[8:11], s32 offen lds
    s_add_u32 m0, s29, 4352
    s_nop 0
    buffer_load_dwordx4 v13, s[8:11], s32 offen lds
    s_add_u32 m0, s29, 8448
    s_nop 0
    buffer_load_dwordx4 v11, s[8:11], s32 offen lds
    s_add_u32 m0, s29, 12544
    s_nop 0
    buffer_load_dwordx4 v12, s[8:11], s32 offen lds
    s_cmp_lg_u32 s23, 0
    s_cbranch_scc1 L_nh5
    s_mov_b32 m0, s30
    s_mov_b64 exec, 0xffff
    buffer_load_dwordx4 v14, s[8:11], s32 offen lds
    s_mov_b64 exec, -1
L_nh5:
    s_waitcnt vmcnt(8)
    s_cmp_eq_u32 s23, 0
    s_cbranch_scc1 L_wh6
    s_waitcnt vmcnt(7)
L_wh6:
    s_barrier
    s_add_u32 m0, s28, 0
    s_nop 0
    buffer_load_dwordx4 v16, s[12:15], s33 offen lds
    s_add_u32 m0, s28, 8192
    s_nop 0
    buffer_load_dwordx4 v17, s[12:15], s33 offen lds
    s_add_u32 m0, s28, 16384
    s_nop 0
    buffer_load_dwordx4 v18, s[12:15], s33 offen lds
    s_waitcnt vmcnt(8)
    s_cmp_eq_u32 s23, 0
    s_cbranch_scc1 L_wh7
    s_waitcnt vmcnt(7)
L_wh7:
    s_barrier
    s_add_u32 m0, s28, 4096
    s_nop 0
    buffer_load_dwordx4 v19, s[12:15], s33 offen lds
    s_add_u32 m0, s28, 12288
    s_nop 0
    buffer_load_dwordx4 v20, s[12:15], s33 offen lds
    s_add_u32 m0, s28, 20480
    s_nop 0
    buffer_load_dwordx4 v21, s[12:15], s33 offen lds
    s_add_u32 s35, s35, 1
    s_cmp_ge_u32 s35, 16
    s_cbranch_scc1 L_nosl8
    s_cmp_eq_u32 s35, 4
    s_cselect_b32 s46, 11, s35
    s_cmp_eq_u32 s35, 11
    s_cselect_b32 s46, 4, s46
    s_bitcmp1_b32 s3, 0
    s_cbranch_scc1 L_odd8
    s_lshl_b32 s34, s46, 17
    s_load_dword s31, s[50:51], s34
    s_load_dword s31, s[52:53], s34
    s_load_dword s31, s[54:55], s34
    s_branch L_nosl8
L_odd8:
    s_add_u32 s34, s49, s35
    s_and_b32 s34, s34, 15
    s_lshl_b32 s34, s34, 11
    s_add_u32 s34, s34, s46
    s_lshl_b32 s34, s34, 7
    s_load_dword s31, s[50:51], s34
L_nosl8:
    s_lshr_b64 s[40:41], s[40:41], 4
    s_and_b32 s32, s40, 15
    s_lshl_b32 s33, s32, 17
    s_lshl_b32 s32, s32, 7
    s_add_u32 s29, s29, -33280
    s_add_u32 s30, s30, -33280
    s_add_u32 s28, s28, -49152
    s_add_u32 m0, s29, 0
    s_nop 0
    buffer_load_dwordx4 v10, s[8:11], s32 offen lds
    s_add_u32 m0, s29, 4352
    s_nop 0
    buffer_load_dwordx4 v13, s[8:11], s32 offen lds
    s_add_u32 m0, s29, 8448
    s_nop 0
    buffer_load_dwordx4 v11, s[8:11], s32 offen lds
    s_add_u32 m0, s29, 12544
    s_nop 0
    buffer_load_dwordx4 v12, s[8:11], s32 offen lds
    s_cmp_lg_u32 s23, 0
    s_cbranch_scc1 L_nh9
    s_mov_b32 m0, s30
    s_mov_b64 exec, 0xffff
    buffer_load_dwordx4 v14, s[8:11], s32 offen lds
    s_mov_b64 exec, -1
L_nh9:
    s_waitcnt vmcnt(8)
    s_cmp_eq_u32 s23, 0
    s_cbranch_scc1 L_wh10
    s_waitcnt vmcnt(7)
L_wh10:
    s_barrier
    s_add_u32 m0, s28, 0
    s_nop 0
    buffer_load_dwordx4 v16, s[12:15], s33 offen lds
    s_add_u32 m0, s28, 8192
    s_nop 0
    buffer_load_dwordx4 v17, s[12:15], s33 offen lds
    s_add_u32 m0, s28, 16384
    s_nop 0
    buffer_load_dwordx4 v18, s[12:15], s33 offen lds
    s_waitcnt vmcnt(8)
    s_cmp_eq_u32 s23, 0
    s_cbranch_scc1 L_wh11
    s_waitcnt vmcnt(7)
L_wh11:
    s_barrier
    s_add_u32 m0, s28, 4096
    s_nop 0
    buffer_load_dwordx4 v19, s[12:15], s33 offen lds
    s_add_u32 m0, s28, 12288
    s_nop 0
    buffer_load_dwordx4 v20, s[12:15], s33 offen lds
    s_add_u32 m0, s28, 20480
    s_nop 0
    buffer_load_dwordx4 v21, s[12:15], s33 offen lds
    s_add_u32 s35, s35, 1
    s_cmp_ge_u32 s35, 16
    s_cbranch_scc1 L_nosl12
    s_cmp_eq_u32 s35, 4
    s_cselect_b32 s46, 11, s35
    s_cmp_eq_u32 s35, 11
    s_cselect_b32 s46, 4, s46
    s_bitcmp1_b32 s3, 0
    s_cbranch_scc1 L_odd12
    s_lshl_b32 s34, s46, 17
    s_load_dword s31, s[50:51], s34
    s_load_dword s31, s[52:53], s34
    s_load_dword s31, s[54:55], s34
    s_branch L_nosl12
L_odd12:
    s_add_u32 s34, s49, s35
    s_and_b32 s34, s34, 15
    s_lshl_b32 s34, s34, 11
    s_add_u32 s34, s34, s46
    s_lshl_b32 s34, s34, 7
    s_load_dword s31, s[50:51], s34
L_nosl12:
    s_lshr_b64 s[40:41], s[40:41], 4
    s_and_b32 s32, s40, 15
    s_lshl_b32 s33, s32, 17
    s_lshl_b32 s32, s32, 7
    s_add_u32 s29, s29, 16640
    s_add_u32 s30, s30, 16640
    s_add_u32 s28, s28, 24576
    s_mov_b32 s42, 4
    s_mov_b32 s36, 1
    s_mov_b32 m0, s29
    s_branch L_ld1
L_ld:
    s_barrier
L_ld1:
    buffer_load_dwordx4 v10, s[8:11], s32 offen lds
    s_add_u32 m0, s29, 4352
    s_lshr_b64 s[40:41], s[40:41], 4
    buffer_load_dwordx4 v13, s[8:11], s32 offen lds
    s_add_u32 m0, s29, 8448
    s_and_b32 s44, s40, 15
    buffer_load_dwordx4 v11, s[8:11], s32 offen lds
    s_add_u32 m0, s29, 12544
    s_add_u32 s36, s36, 1
    buffer_load_dwordx4 v12, s[8:11], s32 offen lds
    s_cmp_lg_u32 s23, 0
    s_cbranch_scc1 L_nh13
    s_mov_b32 m0, s30
    s_mov_b64 exec, 0xffff
    buffer_load_dwordx4 v14, s[8:11], s32 offen lds
    s_mov_b64 exec, -1
L_nh13:
    s_cmp_eq_u32 s36, 3
    s_cselect_b32 s45, -2, 1
    s_cselect_b32 s36, 0, s36
    s_add_u32 m0, s28, 0
    s_mul_i32 s38, s45, 16640
    buffer_load_dwordx4 v16, s[12:15], s33 offen lds
    s_add_u32 m0, s28, 8192
    s_lshl_b32 s32, s44, 7
    buffer_load_dwordx4 v17, s[12:15], s33 offen lds
    s_add_u32 m0, s28, 16384
    s_add_u32 s29, s29, s38
    buffer_load_dwordx4 v18, s[12:15], s33 offen lds
    s_add_u32 m0, s28, 4096
    s_add_u32 s30, s30, s38
    buffer_load_dwordx4 v19, s[12:15], s33 offen lds
    s_add_u32 m0, s28, 12288
    s_mul_i32 s37, s45, 24576
    buffer_load_dwordx4 v20, s[12:15], s33 offen lds
    s_add_u32 m0, s28, 20480
    s_add_u32 s42, s42, 1
    buffer_load_dwordx4 v21, s[12:15], s33 offen lds
    s_add_u32 s28, s28, s37
    s_lshl_b32 s33, s44, 17
    s_mov_b32 m0, s29
    s_add_u32 s35, s35, 1
    s_cmp_ge_u32 s35, 16
    s_cbranch_scc1 L_nosl14
    s_cmp_eq_u32 s35, 4
    s_cselect_b32 s46, 11, s35
    s_cmp_eq_u32 s35, 11
    s_cselect_b32 s46, 4, s46
    s_bitcmp1_b32 s3, 0
    s_cbranch_scc1 L_odd14
    s_lshl_b32 s34, s46, 17
    s_load_dword s31, s[50:51], s34
    s_load_dword s31, s[52:53], s34
    s_load_dword s31, s[54:55], s34
    s_branch L_nosl14
L_odd14:
    s_add_u32 s34, s49, s35
    s_and_b32 s34, s34, 15
    s_lshl_b32 s34, s34, 11
    s_add_u32 s34, s34, s46
    s_lshl_b32 s34, s34, 7
    s_load_dword s31, s[50:51], s34
L_nosl14:
    s_waitcnt vmcnt(11)
    s_cmp_eq_u32 s23, 0
    s_cbranch_scc1 L_wh15
    s_waitcnt vmcnt(10)
L_wh15:
    s_cmp_lt_u32 s42, 16
    s_cbranch_scc1 L_ld
    s_barrier
    s_getpc_b64 s[44:45]
L_pc2:
    s_add_u32 s44, s44, L_fin-3072-L_pc2
    s_addc_u32 s45, s45, 0
    s_mul_i32 s37, s23, 768
    v_lshl_add_u32 v6, v0, 7, s37
    s_mov_b64 exec, 63
    global_load_dword v6, v6, s[44:45]
    s_waitcnt vmcnt(4)
    s_barrier
    s_waitcnt vmcnt(1)
    s_barrier
    s_endpgm
.p2align 12
L_cons:
    s_mov_b32 s6, 0
    s_and_b32 s23, s21, 7
    s_lshl3_add_u32 s26, s20, s23
    s_lshl_b32 s22, s26, 7
    s_lshr_b32 s23, s21, 3
    s_lshl2_add_u32 s27, s3, s23
    s_lshl_b32 s24, s27, 7
    s_and_b32 s4, s26, 1
    v_and_b32 v14, 15, v0
    v_lshrrev_b32 v15, 4, v0
    v_add_u32 v16, 4, v14
    v_bfe_u32 v16, v16, 3, 1
    v_and_b32 v17, 7, v14
    v_lshl_add_u32 v16, v17, 1, v16
    s_lshr_b32 s29, s25, 1
    s_and_b32 s27, s25, 1
    s_lshl_b32 s28, s29, 4
    v_add_u32 v16, s28, v16
    s_lshl_b32 s28, s4, 2
    v_xor_b32 v21, s28, v15
    v_add_u32 v17, -1, v16
    v_bfe_u32 v18, v17, 1, 3
    v_xor_b32 v18, v18, v21
    v_lshlrev_b32 v18, 4, v18
    v_lshl_add_u32 v2, v17, 7, v18
    v_add_u32 v2, 4352, v2
    v_xor_b32 v3, 64, v2
    v_add_u32 v17, 0, v16
    v_bfe_u32 v18, v17, 1, 3
    v_xor_b32 v18, v18, v21
    v_lshlrev_b32 v18, 4, v18
    v_lshl_add_u32 v4, v17, 7, v18
    v_xor_b32 v5, 64, v4
    v_add_u32 v17, 1, v16
    v_bfe_u32 v18, v17, 1, 3
    v_xor_b32 v18, v18, v21
    v_lshlrev_b32 v18, 4, v18
    v_lshl_add_u32 v6, v17, 7, v18
    v_xor_b32 v7, 64, v6
    v_bfe_u32 v17, v0, 2, 2
    v_lshl_add_u32 v18, v15, 3, v17
    v_lshlrev_b32 v18, 7, v18
    v_and_b32 v19, 3, v0
    v_lshl_add_u32 v18, v19, 3, v18
    v_and_b32 v20, 1, v17
    v_lshl_add_u32 v20, v20, 2, v15
    v_lshl_add_u32 v20, v20, 2, v19
    s_lshl_b32 s28, s27, 6
    s_add_u32 s28, s28, 123648
    v_lshl_add_u32 v13, v20, 1, s28
    v_lshrrev_b32 v17, 1, v17
    v_and_b32 v19, 1, v15
    v_lshl_or_b32 v17, v19, 1, v17
    s_lshl_b32 s28, s27, 1
    v_xor_b32 v17, s28, v17
    v_lshl_add_u32 v8, v17, 5, v18
    v_add_u32 v8, 49920, v8
    v_xor_b32 v9, 32, v8
    v_add_u32 v10, 49152, v8
    v_add_u32 v11, 49152, v9
    v_lshlrev_b32 v17, 2, v16
    v_add_u32 v17, s22, v17
    v_lshlrev_b32 v17, 11, v17
    v_and_b32 v18, 1, v15
    v_lshlrev_b32 v18, 5, v18
    v_lshrrev_b32 v19, 1, v15
    v_lshl_add_u32 v18, v19, 4, v18
    s_lshl_b32 s28, s27, 6
    s_add_u32 s28, s28, s24
    v_add3_u32 v12, v17, v18, s28
    s_mov_b32 s18, 0x400000
    s_mov_b32 s19, 0x20000
    s_mov_b32 s58, 4096
    s_mov_b32 s59, 0xbfb8aa3b
    s_waitcnt lgkmcnt(0)
    s_mov_b32 s16, s92
    s_and_b32 s17, s93, 0xffff
    v_and_b32 v14, 12, v0
    v_bfe_u32 v17, v0, 4, 1
    v_lshl_or_b32 v14, v17, 1, v14
    v_lshrrev_b32 v17, 5, v0
    v_or_b32 v14, v14, v17
    v_add_u32 v16, 4, v14
    v_bfe_u32 v16, v16, 3, 1
    v_and_b32 v17, 7, v14
    v_lshl_add_u32 v16, v17, 1, v16
    s_lshl_b32 s5, s29, 6
    s_add_u32 s5, s5, s22
    v_lshl_add_u32 v16, v16, 2, s5
    v_lshlrev_b32 v16, 11, v16
    v_and_b32 v17, 1, v0
    v_lshlrev_b32 v17, 5, v17
    v_and_b32 v18, 2, v0
    v_lshl_add_u32 v17, v18, 3, v17
    v_add3_u32 v14, v16, v17, s28
    s_mov_b32 s8, 0x55555555
    s_mov_b32 s9, s8
    s_mov_b32 s10, 0x33333333
    s_mov_b32 s11, s10
    s_mov_b32 s30, 3
L_main:
    s_barrier
    ds_read_b64_tr_b16 v[96:97], v8 offset:0
    ds_read_b64_tr_b16 v[98:99], v8 offset:512
    ds_read_b128 v[72:75], v2 offset:0
    ds_read_b64_tr_b16 v[104:105], v8 offset:8192
    ds_read_b64_tr_b16 v[106:107], v8 offset:8704
    ds_read_b128 v[76:79], v4 offset:0
    ds_read_b64_tr_b16 v[112:113], v8 offset:16384
    ds_read_b64_tr_b16 v[114:115], v8 offset:16896
    ds_read_b128 v[80:83], v4 offset:8448
    ds_read_b64_tr_b16 v[116:117], v9 offset:16384
    ds_read_b64_tr_b16 v[118:119], v9 offset:16896
    ds_read_b64_tr_b16 v[108:109], v9 offset:8192
    ds_read_b64_tr_b16 v[110:111], v9 offset:8704
    ds_read_b64_tr_b16 v[100:101], v9 offset:0
    ds_read_b64_tr_b16 v[102:103], v9 offset:512
    s_waitcnt lgkmcnt(12)
    v_mfma_f32_16x16x32_bf16 v[16:19], v[96:99], v[72:75], 0
    s_waitcnt lgkmcnt(9)
    v_mfma_f32_16x16x32_bf16 v[16:19], v[104:107], v[76:79], v[16:19]
    ds_read_b128 v[84:87], v4 offset:12544
    s_waitcnt lgkmcnt(7)
    v_mfma_f32_16x16x32_bf16 v[16:19], v[112:115], v[80:83], v[16:19]
    ds_read_b128 v[88:91], v4 offset:4352
    s_waitcnt lgkmcnt(6)
    v_mfma_f32_16x16x32_bf16 v[20:23], v[116:119], v[80:83], 0
    ds_read_b128 v[92:95], v6 offset:0
    s_waitcnt lgkmcnt(5)
    v_mfma_f32_16x16x32_bf16 v[20:23], v[108:111], v[76:79], v[20:23]
    s_barrier
    ds_read_b64_tr_b16 v[144:145], v8 offset:4096
    s_waitcnt lgkmcnt(4)
    v_mfma_f32_16x16x32_bf16 v[20:23], v[100:103], v[72:75], v[20:23]
    ds_read_b64_tr_b16 v[146:147], v8 offset:4608
    v_mfma_f32_16x16x32_bf16 v[28:31], v[100:103], v[76:79], 0
    ds_read_b128 v[120:123], v3 offset:0
    v_mfma_f32_16x16x32_bf16 v[28:31], v[108:111], v[80:83], v[28:31]
    ds_read_b64_tr_b16 v[152:153], v8 offset:12288
    s_waitcnt lgkmcnt(6)
    v_mfma_f32_16x16x32_bf16 v[28:31], v[116:119], v[84:87], v[28:31]
    ds_read_b64_tr_b16 v[154:155], v8 offset:12800
    v_mfma_f32_16x16x32_bf16 v[24:27], v[112:115], v[84:87], 0
    ds_read_b128 v[124:127], v5 offset:0
    v_mfma_f32_16x16x32_bf16 v[24:27], v[104:107], v[80:83], v[24:27]
    ds_read_b64_tr_b16 v[160:161], v8 offset:20480
    v_mfma_f32_16x16x32_bf16 v[24:27], v[96:99], v[76:79], v[24:27]
    ds_read_b64_tr_b16 v[162:163], v8 offset:20992
    v_mfma_f32_16x16x32_bf16 v[32:35], v[96:99], v[80:83], 0
    ds_read_b128 v[128:131], v5 offset:8448
    v_mfma_f32_16x16x32_bf16 v[32:35], v[104:107], v[84:87], v[32:35]
    ds_read_b64_tr_b16 v[164:165], v9 offset:20480
    s_waitcnt lgkmcnt(6)
    v_mfma_f32_16x16x32_bf16 v[32:35], v[112:115], v[88:91], v[32:35]
    ds_read_b64_tr_b16 v[166:167], v9 offset:20992
    v_mfma_f32_16x16x32_bf16 v[36:39], v[116:119], v[88:91], 0
    ds_read_b64_tr_b16 v[156:157], v9 offset:12288
    v_mfma_f32_16x16x32_bf16 v[36:39], v[108:111], v[84:87], v[36:39]
    ds_read_b64_tr_b16 v[158:159], v9 offset:12800
    v_mfma_f32_16x16x32_bf16 v[36:39], v[100:103], v[80:83], v[36:39]
    ds_read_b64_tr_b16 v[148:149], v9 offset:4096
    v_mfma_f32_16x16x32_bf16 v[44:47], v[100:103], v[84:87], 0
    ds_read_b64_tr_b16 v[150:151], v9 offset:4608
    v_mfma_f32_16x16x32_bf16 v[44:47], v[108:111], v[88:91], v[44:47]
    ds_read_u16 v64, v13 offset:0
    v_mfma_f32_16x16x32_bf16 v[44:47], v[116:119], v[92:95], v[44:47]
    ds_read_u16 v65, v13 offset:128
    v_mfma_f32_16x16x32_bf16 v[40:43], v[112:115], v[92:95], 0
    ds_read_u16 v66, v13 offset:256
    v_mfma_f32_16x16x32_bf16 v[40:43], v[104:107], v[88:91], v[40:43]
    ds_read_u16 v67, v13 offset:384
    v_mfma_f32_16x16x32_bf16 v[40:43], v[96:99], v[84:87], v[40:43]
    ds_read_b128 v[132:135], v5 offset:12544
    v_mfma_f32_16x16x32_bf16 v[16:19], v[144:147], v[120:123], v[16:19]
    ds_read_b128 v[136:139], v5 offset:4352
    s_waitcnt lgkmcnt(6)
    v_mfma_f32_16x16x32_bf16 v[16:19], v[152:155], v[124:127], v[16:19]
    ds_read_b128 v[140:143], v7 offset:0
    v_mfma_f32_16x16x32_bf16 v[16:19], v[160:163], v[128:131], v[16:19]
    v_mfma_f32_16x16x32_bf16 v[20:23], v[164:167], v[128:131], v[20:23]
    v_mfma_f32_16x16x32_bf16 v[20:23], v[156:159], v[124:127], v[20:23]
    v_mfma_f32_16x16x32_bf16 v[20:23], v[148:151], v[120:123], v[20:23]
    v_mfma_f32_16x16x32_bf16 v[28:31], v[148:151], v[124:127], v[28:31]
    v_mfma_f32_16x16x32_bf16 v[28:31], v[156:159], v[128:131], v[28:31]
    s_waitcnt lgkmcnt(0)
    v_mfma_f32_16x16x32_bf16 v[28:31], v[164:167], v[132:135], v[28:31]
    s_barrier
    ds_read_b64_tr_b16 v[192:193], v8 offset:24576
    v_mfma_f32_16x16x32_bf16 v[24:27], v[160:163], v[132:135], v[24:27]
    ds_read_b64_tr_b16 v[194:195], v8 offset:25088
    v_mfma_f32_16x16x32_bf16 v[24:27], v[152:155], v[128:131], v[24:27]
    ds_read_b128 v[168:171], v2 offset:16640
    v_mfma_f32_16x16x32_bf16 v[24:27], v[144:147], v[124:127], v[24:27]
    ds_read_b64_tr_b16 v[200:201], v8 offset:32768
    v_mfma_f32_16x16x32_bf16 v[32:35], v[144:147], v[128:131], v[32:35]
    ds_read_b64_tr_b16 v[202:203], v8 offset:33280
    v_mfma_f32_16x16x32_bf16 v[32:35], v[152:155], v[132:135], v[32:35]
    ds_read_b128 v[172:175], v4 offset:16640
    v_mfma_f32_16x16x32_bf16 v[32:35], v[160:163], v[136:139], v[32:35]
    ds_read_b64_tr_b16 v[208:209], v8 offset:40960
    v_mfma_f32_16x16x32_bf16 v[36:39], v[164:167], v[136:139], v[36:39]
    ds_read_b64_tr_b16 v[210:211], v8 offset:41472
    v_mfma_f32_16x16x32_bf16 v[36:39], v[156:159], v[132:135], v[36:39]
    ds_read_b128 v[176:179], v4 offset:25088
    v_mfma_f32_16x16x32_bf16 v[36:39], v[148:151], v[128:131], v[36:39]
    ds_read_b64_tr_b16 v[212:213], v9 offset:40960
    v_mfma_f32_16x16x32_bf16 v[44:47], v[148:151], v[132:135], v[44:47]
    ds_read_b64_tr_b16 v[214:215], v9 offset:41472
    v_mfma_f32_16x16x32_bf16 v[44:47], v[156:159], v[136:139], v[44:47]
    ds_read_b64_tr_b16 v[204:205], v9 offset:32768
    v_mfma_f32_16x16x32_bf16 v[44:47], v[164:167], v[140:143], v[44:47]
    ds_read_b64_tr_b16 v[206:207], v9 offset:33280
    v_mfma_f32_16x16x32_bf16 v[40:43], v[160:163], v[140:143], v[40:43]
    ds_read_b64_tr_b16 v[196:197], v9 offset:24576
    v_mfma_f32_16x16x32_bf16 v[40:43], v[152:155], v[136:139], v[40:43]
    ds_read_b64_tr_b16 v[198:199], v9 offset:25088
    v_mfma_f32_16x16x32_bf16 v[40:43], v[144:147], v[132:135], v[40:43]
    ds_read_b128 v[180:183], v4 offset:29184
    s_waitcnt lgkmcnt(6)
    v_mfma_f32_16x16x32_bf16 v[16:19], v[192:195], v[168:171], v[16:19]
    ds_read_b128 v[184:187], v4 offset:20992
    v_mfma_f32_16x16x32_bf16 v[16:19], v[200:203], v[172:175], v[16:19]
    ds_read_b128 v[188:191], v6 offset:16640
    v_mfma_f32_16x16x32_bf16 v[16:19], v[208:211], v[176:179], v[16:19]
    s_barrier
    ds_read_b64_tr_b16 v[96:97], v8 offset:28672
    s_waitcnt lgkmcnt(6)
    v_mfma_f32_16x16x32_bf16 v[20:23], v[212:215], v[176:179], v[20:23]
    ds_read_b64_tr_b16 v[98:99], v8 offset:29184
    v_mfma_f32_16x16x32_bf16 v[20:23], v[204:207], v[172:175], v[20:23]
    ds_read_b128 v[72:75], v3 offset:16640
    s_waitcnt lgkmcnt(6)
    v_mfma_f32_16x16x32_bf16 v[20:23], v[196:199], v[168:171], v[20:23]
    ds_read_b64_tr_b16 v[104:105], v8 offset:36864
    v_mfma_f32_16x16x32_bf16 v[28:31], v[196:199], v[172:175], v[28:31]
    ds_read_b64_tr_b16 v[106:107], v8 offset:37376
    v_mfma_f32_16x16x32_bf16 v[28:31], v[204:207], v[176:179], v[28:31]
    ds_read_b128 v[76:79], v5 offset:16640
    s_waitcnt lgkmcnt(6)
    v_mfma_f32_16x16x32_bf16 v[28:31], v[212:215], v[180:183], v[28:31]
    ds_read_b64_tr_b16 v[112:113], v8 offset:45056
    v_mfma_f32_16x16x32_bf16 v[24:27], v[208:211], v[180:183], v[24:27]
    ds_read_b64_tr_b16 v[114:115], v8 offset:45568
    v_mfma_f32_16x16x32_bf16 v[24:27], v[200:203], v[176:179], v[24:27]
    ds_read_b128 v[80:83], v5 offset:25088
    v_mfma_f32_16x16x32_bf16 v[24:27], v[192:195], v[172:175], v[24:27]
    ds_read_b64_tr_b16 v[116:117], v9 offset:45056
    v_mfma_f32_16x16x32_bf16 v[32:35], v[192:195], v[176:179], v[32:35]
    ds_read_b64_tr_b16 v[118:119], v9 offset:45568
    v_mfma_f32_16x16x32_bf16 v[32:35], v[200:203], v[180:183], v[32:35]
    ds_read_b64_tr_b16 v[108:109], v9 offset:36864
    v_mfma_f32_16x16x32_bf16 v[32:35], v[208:211], v[184:187], v[32:35]
    ds_read_b64_tr_b16 v[110:111], v9 offset:37376
    v_mfma_f32_16x16x32_bf16 v[36:39], v[212:215], v[184:187], v[36:39]
    ds_read_b64_tr_b16 v[100:101], v9 offset:28672
    v_mfma_f32_16x16x32_bf16 v[36:39], v[204:207], v[180:183], v[36:39]
    ds_read_b64_tr_b16 v[102:103], v9 offset:29184
    v_mfma_f32_16x16x32_bf16 v[36:39], v[196:199], v[176:179], v[36:39]
    ds_read_b128 v[84:87], v5 offset:29184
    v_mfma_f32_16x16x32_bf16 v[44:47], v[196:199], v[180:183], v[44:47]
    ds_read_b128 v[88:91], v5 offset:20992
    v_mfma_f32_16x16x32_bf16 v[44:47], v[204:207], v[184:187], v[44:47]
    ds_read_b128 v[92:95], v7 offset:16640
    v_mfma_f32_16x16x32_bf16 v[44:47], v[212:215], v[188:191], v[44:47]
    v_mfma_f32_16x16x32_bf16 v[40:43], v[208:211], v[188:191], v[40:43]
    v_mfma_f32_16x16x32_bf16 v[40:43], v[200:203], v[184:187], v[40:43]
    v_mfma_f32_16x16x32_bf16 v[40:43], v[192:195], v[180:183], v[40:43]
    s_waitcnt lgkmcnt(2)
    v_mfma_f32_16x16x32_bf16 v[16:19], v[96:99], v[72:75], v[16:19]
    v_mfma_f32_16x16x32_bf16 v[16:19], v[104:107], v[76:79], v[16:19]
    s_waitcnt lgkmcnt(0)
    v_mfma_f32_16x16x32_bf16 v[16:19], v[112:115], v[80:83], v[16:19]
    s_barrier
    ds_read_b64_tr_b16 v[144:145], v10 offset:0
    v_mfma_f32_16x16x32_bf16 v[20:23], v[116:119], v[80:83], v[20:23]
    ds_read_b64_tr_b16 v[146:147], v10 offset:512
    v_mfma_f32_16x16x32_bf16 v[20:23], v[108:111], v[76:79], v[20:23]
    ds_read_b128 v[120:123], v2 offset:33280
    v_mfma_f32_16x16x32_bf16 v[20:23], v[100:103], v[72:75], v[20:23]
    ds_read_b64_tr_b16 v[152:153], v10 offset:8192
    v_mfma_f32_16x16x32_bf16 v[28:31], v[100:103], v[76:79], v[28:31]
    ds_read_b64_tr_b16 v[154:155], v10 offset:8704
    v_mfma_f32_16x16x32_bf16 v[28:31], v[108:111], v[80:83], v[28:31]
    ds_read_b128 v[124:127], v4 offset:33280
    v_mfma_f32_16x16x32_bf16 v[28:31], v[116:119], v[84:87], v[28:31]
    ds_read_b64_tr_b16 v[160:161], v10 offset:16384
    v_mfma_f32_16x16x32_bf16 v[24:27], v[112:115], v[84:87], v[24:27]
    ds_read_b64_tr_b16 v[162:163], v10 offset:16896
    v_mfma_f32_16x16x32_bf16 v[24:27], v[104:107], v[80:83], v[24:27]
    ds_read_b128 v[128:131], v4 offset:41728
    v_mfma_f32_16x16x32_bf16 v[24:27], v[96:99], v[76:79], v[24:27]
    ds_read_b64_tr_b16 v[164:165], v11 offset:16384
    v_mfma_f32_16x16x32_bf16 v[32:35], v[96:99], v[80:83], v[32:35]
    ds_read_b64_tr_b16 v[166:167], v11 offset:16896
    v_mfma_f32_16x16x32_bf16 v[32:35], v[104:107], v[84:87], v[32:35]
    ds_read_b64_tr_b16 v[156:157], v11 offset:8192
    v_mfma_f32_16x16x32_bf16 v[32:35], v[112:115], v[88:91], v[32:35]
    ds_read_b64_tr_b16 v[158:159], v11 offset:8704
    v_mfma_f32_16x16x32_bf16 v[36:39], v[116:119], v[88:91], v[36:39]
    ds_read_b64_tr_b16 v[148:149], v11 offset:0
    v_mfma_f32_16x16x32_bf16 v[36:39], v[108:111], v[84:87], v[36:39]
    ds_read_b64_tr_b16 v[150:151], v11 offset:512
    v_mfma_f32_16x16x32_bf16 v[36:39], v[100:103], v[80:83], v[36:39]
    ds_read_b128 v[132:135], v4 offset:45824
    v_mfma_f32_16x16x32_bf16 v[44:47], v[100:103], v[84:87], v[44:47]
    ds_read_b128 v[136:139], v4 offset:37632
    v_mfma_f32_16x16x32_bf16 v[44:47], v[108:111], v[88:91], v[44:47]
    ds_read_b128 v[140:143], v6 offset:33280
    v_mfma_f32_16x16x32_bf16 v[44:47], v[116:119], v[92:95], v[44:47]
    s_barrier
    ds_read_b64_tr_b16 v[192:193], v10 offset:4096
    v_mfma_f32_16x16x32_bf16 v[40:43], v[112:115], v[92:95], v[40:43]
    ds_read_b64_tr_b16 v[194:195], v10 offset:4608
    v_mfma_f32_16x16x32_bf16 v[40:43], v[104:107], v[88:91], v[40:43]
    ds_read_b128 v[168:171], v3 offset:33280
    v_mfma_f32_16x16x32_bf16 v[40:43], v[96:99], v[84:87], v[40:43]
    ds_read_b64_tr_b16 v[200:201], v10 offset:12288
    s_waitcnt lgkmcnt(6)
    v_mfma_f32_16x16x32_bf16 v[16:19], v[144:147], v[120:123], v[16:19]
    ds_read_b64_tr_b16 v[202:203], v10 offset:12800
    v_mfma_f32_16x16x32_bf16 v[16:19], v[152:155], v[124:127], v[16:19]
    ds_read_b128 v[172:175], v5 offset:33280
    v_mfma_f32_16x16x32_bf16 v[16:19], v[160:163], v[128:131], v[16:19]
    ds_read_b64_tr_b16 v[208:209], v10 offset:20480
    v_mfma_f32_16x16x32_bf16 v[20:23], v[164:167], v[128:131], v[20:23]
    ds_read_b64_tr_b16 v[210:211], v10 offset:20992
    v_mfma_f32_16x16x32_bf16 v[20:23], v[156:159], v[124:127], v[20:23]
    ds_read_b128 v[176:179], v5 offset:41728
    v_mfma_f32_16x16x32_bf16 v[20:23], v[148:151], v[120:123], v[20:23]
    ds_read_b64_tr_b16 v[212:213], v11 offset:20480
    v_mfma_f32_16x16x32_bf16 v[28:31], v[148:151], v[124:127], v[28:31]
    ds_read_b64_tr_b16 v[214:215], v11 offset:20992
    v_mfma_f32_16x16x32_bf16 v[28:31], v[156:159], v[128:131], v[28:31]
    ds_read_b64_tr_b16 v[204:205], v11 offset:12288
    v_mfma_f32_16x16x32_bf16 v[28:31], v[164:167], v[132:135], v[28:31]
    ds_read_b64_tr_b16 v[206:207], v11 offset:12800
    v_mfma_f32_16x16x32_bf16 v[24:27], v[160:163], v[132:135], v[24:27]
    ds_read_b64_tr_b16 v[196:197], v11 offset:4096
    v_mfma_f32_16x16x32_bf16 v[24:27], v[152:155], v[128:131], v[24:27]
    ds_read_b64_tr_b16 v[198:199], v11 offset:4608
    v_mfma_f32_16x16x32_bf16 v[24:27], v[144:147], v[124:127], v[24:27]
    ds_read_b128 v[180:183], v5 offset:45824
    v_mfma_f32_16x16x32_bf16 v[32:35], v[144:147], v[128:131], v[32:35]
    ds_read_b128 v[184:187], v5 offset:37632
    v_mfma_f32_16x16x32_bf16 v[32:35], v[152:155], v[132:135], v[32:35]
    ds_read_b128 v[188:191], v7 offset:33280
    s_waitcnt lgkmcnt(6)
    v_mfma_f32_16x16x32_bf16 v[32:35], v[160:163], v[136:139], v[32:35]
    v_mfma_f32_16x16x32_bf16 v[36:39], v[164:167], v[136:139], v[36:39]
    v_mfma_f32_16x16x32_bf16 v[36:39], v[156:159], v[132:135], v[36:39]
    v_mfma_f32_16x16x32_bf16 v[36:39], v[148:151], v[128:131], v[36:39]
    v_mfma_f32_16x16x32_bf16 v[44:47], v[148:151], v[132:135], v[44:47]
    v_mfma_f32_16x16x32_bf16 v[44:47], v[156:159], v[136:139], v[44:47]
    s_waitcnt lgkmcnt(0)
    v_mfma_f32_16x16x32_bf16 v[44:47], v[164:167], v[140:143], v[44:47]
    v_lshlrev_b32 v64, 16, v64
    v_lshlrev_b32 v65, 16, v65
    v_lshlrev_b32 v66, 16, v66
    v_lshlrev_b32 v67, 16, v67
    v_add_f32 v65, 0x3727c5ac, v65
    v_cvt_pk_bf16_f32 v65, v65, v65
    v_lshlrev_b32 v65, 16, v65
    v_sqrt_f32 v65, v65
    s_nop 0
    v_cvt_pk_bf16_f32 v65, v65, v65
    v_lshlrev_b32 v65, 16, v65
    v_rcp_f32 v65, v65
    s_nop 0
    v_cvt_pk_bf16_f32 v65, v65, v65
    v_lshlrev_b32 v65, 16, v65
    v_mul_f32 v65, v66, v65
    v_cvt_pk_bf16_f32 v65, v65, v65
    v_lshlrev_b32 v65, 16, v65
    v_fma_f32 v67, -v64, v65, v67
    v_mul_f32 v65, s59, v65
    v_mul_f32 v67, s59, v67
    s_nop 1
    v_mov_b32_dpp v48, v65 row_newbcast:0 row_mask:0xf bank_mask:0xf
    v_mov_b32_dpp v56, v67 row_newbcast:0 row_mask:0xf bank_mask:0xf
    v_mov_b32_dpp v49, v65 row_newbcast:1 row_mask:0xf bank_mask:0xf
    v_mov_b32_dpp v57, v67 row_newbcast:1 row_mask:0xf bank_mask:0xf
    v_mov_b32_dpp v50, v65 row_newbcast:2 row_mask:0xf bank_mask:0xf
    v_mov_b32_dpp v58, v67 row_newbcast:2 row_mask:0xf bank_mask:0xf
    v_mov_b32_dpp v51, v65 row_newbcast:3 row_mask:0xf bank_mask:0xf
    v_mov_b32_dpp v59, v67 row_newbcast:3 row_mask:0xf bank_mask:0xf
    v_mov_b32_dpp v52, v65 row_newbcast:4 row_mask:0xf bank_mask:0xf
    v_mov_b32_dpp v60, v67 row_newbcast:4 row_mask:0xf bank_mask:0xf
    v_mov_b32_dpp v53, v65 row_newbcast:5 row_mask:0xf bank_mask:0xf
    v_mov_b32_dpp v61, v67 row_newbcast:5 row_mask:0xf bank_mask:0xf
    v_mov_b32_dpp v54, v65 row_newbcast:6 row_mask:0xf bank_mask:0xf
    v_mov_b32_dpp v62, v67 row_newbcast:6 row_mask:0xf bank_mask:0xf
    v_mov_b32_dpp v55, v65 row_newbcast:7 row_mask:0xf bank_mask:0xf
    v_mov_b32_dpp v63, v67 row_newbcast:7 row_mask:0xf bank_mask:0xf
    s_barrier
    ds_read_b64_tr_b16 v[96:97], v8 offset:0
    v_mfma_f32_16x16x32_bf16 v[40:43], v[160:163], v[140:143], v[40:43]
    ds_read_b64_tr_b16 v[98:99], v8 offset:512
    v_mfma_f32_16x16x32_bf16 v[40:43], v[152:155], v[136:139], v[40:43]
    ds_read_b128 v[72:75], v2 offset:0
    v_mfma_f32_16x16x32_bf16 v[40:43], v[144:147], v[132:135], v[40:43]
    ds_read_b64_tr_b16 v[104:105], v8 offset:8192
    v_mfma_f32_16x16x32_bf16 v[16:19], v[192:195], v[168:171], v[16:19]
    ds_read_b64_tr_b16 v[106:107], v8 offset:8704
    v_mfma_f32_16x16x32_bf16 v[16:19], v[200:203], v[172:175], v[16:19]
    ds_read_b128 v[76:79], v4 offset:0
    v_mfma_f32_16x16x32_bf16 v[16:19], v[208:211], v[176:179], v[16:19]
    ds_read_b64_tr_b16 v[112:113], v8 offset:16384
    v_mfma_f32_16x16x32_bf16 v[20:23], v[212:215], v[176:179], v[20:23]
    ds_read_b64_tr_b16 v[114:115], v8 offset:16896
    v_mfma_f32_16x16x32_bf16 v[20:23], v[204:207], v[172:175], v[20:23]
    ds_read_b128 v[80:83], v4 offset:8448
    v_mfma_f32_16x16x32_bf16 v[20:23], v[196:199], v[168:171], v[20:23]
    ds_read_b64_tr_b16 v[116:117], v9 offset:16384
    v_mfma_f32_16x16x32_bf16 v[28:31], v[196:199], v[172:175], v[28:31]
    ds_read_b64_tr_b16 v[118:119], v9 offset:16896
    v_mfma_f32_16x16x32_bf16 v[28:31], v[204:207], v[176:179], v[28:31]
    ds_read_b64_tr_b16 v[108:109], v9 offset:8192
    v_mfma_f32_16x16x32_bf16 v[28:31], v[212:215], v[180:183], v[28:31]
    ds_read_b64_tr_b16 v[110:111], v9 offset:8704
    v_mfma_f32_16x16x32_bf16 v[24:27], v[208:211], v[180:183], v[24:27]
    ds_read_b64_tr_b16 v[100:101], v9 offset:0
    v_mfma_f32_16x16x32_bf16 v[24:27], v[200:203], v[176:179], v[24:27]
    ds_read_b64_tr_b16 v[102:103], v9 offset:512
    v_mfma_f32_16x16x32_bf16 v[24:27], v[192:195], v[172:175], v[24:27]
    v_mfma_f32_16x16x32_bf16 v[32:35], v[192:195], v[176:179], v[32:35]
    v_mfma_f32_16x16x32_bf16 v[32:35], v[200:203], v[180:183], v[32:35]
    ds_read_b128 v[84:87], v4 offset:12544
    v_mfma_f32_16x16x32_bf16 v[32:35], v[208:211], v[184:187], v[32:35]
    v_mfma_f32_16x16x32_bf16 v[36:39], v[212:215], v[184:187], v[36:39]
    v_mfma_f32_16x16x32_bf16 v[36:39], v[204:207], v[180:183], v[36:39]
    v_mfma_f32_16x16x32_bf16 v[36:39], v[196:199], v[176:179], v[36:39]
    v_mfma_f32_16x16x32_bf16 v[44:47], v[196:199], v[180:183], v[44:47]
    ds_read_b128 v[88:91], v4 offset:4352
    v_mfma_f32_16x16x32_bf16 v[44:47], v[204:207], v[184:187], v[44:47]
    ds_read_b128 v[92:95], v6 offset:0
    v_mfma_f32_16x16x32_bf16 v[44:47], v[212:215], v[188:191], v[44:47]
    ds_read_b64_tr_b16 v[144:145], v8 offset:4096
    v_mfma_f32_16x16x32_bf16 v[40:43], v[208:211], v[188:191], v[40:43]
    ds_read_b64_tr_b16 v[146:147], v8 offset:4608
    v_mfma_f32_16x16x32_bf16 v[40:43], v[200:203], v[184:187], v[40:43]
    ds_read_b128 v[120:123], v3 offset:0
    v_mfma_f32_16x16x32_bf16 v[40:43], v[192:195], v[180:183], v[40:43]
    ds_read_b64_tr_b16 v[152:153], v8 offset:12288
    s_waitcnt lgkmcnt(6)
    v_mfma_f32_16x16x32_bf16 v[16:19], v[96:99], v[72:75], v[16:19]
    ds_read_b64_tr_b16 v[154:155], v8 offset:12800
    v_mfma_f32_16x16x32_bf16 v[16:19], v[104:107], v[76:79], v[16:19]
    ds_read_b128 v[124:127], v5 offset:0
    v_mfma_f32_16x16x32_bf16 v[16:19], v[112:115], v[80:83], v[16:19]
    ds_read_b64_tr_b16 v[160:161], v8 offset:20480
    v_mfma_f32_16x16x32_bf16 v[20:23], v[116:119], v[80:83], v[20:23]
    ds_read_b64_tr_b16 v[162:163], v8 offset:20992
    v_mfma_f32_16x16x32_bf16 v[20:23], v[108:111], v[76:79], v[20:23]
    ds_read_b128 v[128:131], v5 offset:8448
    v_mfma_f32_16x16x32_bf16 v[20:23], v[100:103], v[72:75], v[20:23]
    ds_read_b64_tr_b16 v[164:165], v9 offset:20480
    v_mfma_f32_16x16x32_bf16 v[28:31], v[100:103], v[76:79], v[28:31]
    ds_read_b64_tr_b16 v[166:167], v9 offset:20992
    v_mfma_f32_16x16x32_bf16 v[28:31], v[108:111], v[80:83], v[28:31]
    ds_read_b64_tr_b16 v[156:157], v9 offset:12288
    v_mfma_f32_16x16x32_bf16 v[28:31], v[116:119], v[84:87], v[28:31]
    ds_read_b64_tr_b16 v[158:159], v9 offset:12800
    v_mfma_f32_16x16x32_bf16 v[24:27], v[112:115], v[84:87], v[24:27]
    ds_read_b64_tr_b16 v[148:149], v9 offset:4096
    v_mfma_f32_16x16x32_bf16 v[24:27], v[104:107], v[80:83], v[24:27]
    ds_read_b64_tr_b16 v[150:151], v9 offset:4608
    v_mfma_f32_16x16x32_bf16 v[24:27], v[96:99], v[76:79], v[24:27]
    ds_read_b128 v[132:135], v5 offset:12544
    v_mfma_f32_16x16x32_bf16 v[32:35], v[96:99], v[80:83], v[32:35]
    ds_read_b128 v[136:139], v5 offset:4352
    v_mfma_f32_16x16x32_bf16 v[32:35], v[104:107], v[84:87], v[32:35]
    ds_read_b128 v[140:143], v7 offset:0
    s_waitcnt lgkmcnt(6)
    v_mfma_f32_16x16x32_bf16 v[32:35], v[112:115], v[88:91], v[32:35]
    v_mfma_f32_16x16x32_bf16 v[36:39], v[116:119], v[88:91], v[36:39]
    v_mfma_f32_16x16x32_bf16 v[36:39], v[108:111], v[84:87], v[36:39]
    v_mfma_f32_16x16x32_bf16 v[36:39], v[100:103], v[80:83], v[36:39]
    v_mfma_f32_16x16x32_bf16 v[44:47], v[100:103], v[84:87], v[44:47]
    v_mfma_f32_16x16x32_bf16 v[44:47], v[108:111], v[88:91], v[44:47]
    s_waitcnt lgkmcnt(0)
    v_mfma_f32_16x16x32_bf16 v[44:47], v[116:119], v[92:95], v[44:47]
    s_barrier
    ds_read_b64_tr_b16 v[192:193], v8 offset:24576
    v_mfma_f32_16x16x32_bf16 v[40:43], v[112:115], v[92:95], v[40:43]
    ds_read_b64_tr_b16 v[194:195], v8 offset:25088
    v_mfma_f32_16x16x32_bf16 v[40:43], v[104:107], v[88:91], v[40:43]
    ds_read_b128 v[168:171], v2 offset:16640
    v_mfma_f32_16x16x32_bf16 v[40:43], v[96:99], v[84:87], v[40:43]
    ds_read_b64_tr_b16 v[200:201], v8 offset:32768
    v_mfma_f32_16x16x32_bf16 v[16:19], v[144:147], v[120:123], v[16:19]
    ds_read_b64_tr_b16 v[202:203], v8 offset:33280
    v_mfma_f32_16x16x32_bf16 v[16:19], v[152:155], v[124:127], v[16:19]
    ds_read_b128 v[172:175], v4 offset:16640
    v_mfma_f32_16x16x32_bf16 v[16:19], v[160:163], v[128:131], v[16:19]
    ds_read_b64_tr_b16 v[208:209], v8 offset:40960
    v_mfma_f32_16x16x32_bf16 v[20:23], v[164:167], v[128:131], v[20:23]
    ds_read_b64_tr_b16 v[210:211], v8 offset:41472
    v_mfma_f32_16x16x32_bf16 v[20:23], v[156:159], v[124:127], v[20:23]
    ds_read_b128 v[176:179], v4 offset:25088
    v_mfma_f32_16x16x32_bf16 v[20:23], v[148:151], v[120:123], v[20:23]
    ds_read_b64_tr_b16 v[212:213], v9 offset:40960
    v_mfma_f32_16x16x32_bf16 v[28:31], v[148:151], v[124:127], v[28:31]
    ds_read_b64_tr_b16 v[214:215], v9 offset:41472
    v_mfma_f32_16x16x32_bf16 v[28:31], v[156:159], v[128:131], v[28:31]
    ds_read_b64_tr_b16 v[204:205], v9 offset:32768
    v_mfma_f32_16x16x32_bf16 v[28:31], v[164:167], v[132:135], v[28:31]
    ds_read_b64_tr_b16 v[206:207], v9 offset:33280
    v_mfma_f32_16x16x32_bf16 v[24:27], v[160:163], v[132:135], v[24:27]
    ds_read_b64_tr_b16 v[196:197], v9 offset:24576
    v_mfma_f32_16x16x32_bf16 v[24:27], v[152:155], v[128:131], v[24:27]
    ds_read_b64_tr_b16 v[198:199], v9 offset:25088
    v_mfma_f32_16x16x32_bf16 v[24:27], v[144:147], v[124:127], v[24:27]
    v_mfma_f32_16x16x32_bf16 v[32:35], v[144:147], v[128:131], v[32:35]
    v_mfma_f32_16x16x32_bf16 v[32:35], v[152:155], v[132:135], v[32:35]
    ds_read_b128 v[180:183], v4 offset:29184
    v_mfma_f32_16x16x32_bf16 v[32:35], v[160:163], v[136:139], v[32:35]
    v_mfma_f32_16x16x32_bf16 v[36:39], v[164:167], v[136:139], v[36:39]
    v_mfma_f32_16x16x32_bf16 v[36:39], v[156:159], v[132:135], v[36:39]
    v_mfma_f32_16x16x32_bf16 v[36:39], v[148:151], v[128:131], v[36:39]
    v_mfma_f32_16x16x32_bf16 v[44:47], v[148:151], v[132:135], v[44:47]
    ds_read_b128 v[184:187], v4 offset:20992
    v_mfma_f32_16x16x32_bf16 v[44:47], v[156:159], v[136:139], v[44:47]
    ds_read_b128 v[188:191], v6 offset:16640
    v_mfma_f32_16x16x32_bf16 v[44:47], v[164:167], v[140:143], v[44:47]
    ds_read_b64_tr_b16 v[96:97], v8 offset:28672
    v_mfma_f32_16x16x32_bf16 v[40:43], v[160:163], v[140:143], v[40:43]
    ds_read_b64_tr_b16 v[98:99], v8 offset:29184
    v_mfma_f32_16x16x32_bf16 v[40:43], v[152:155], v[136:139], v[40:43]
    ds_read_b128 v[72:75], v3 offset:16640
    v_mfma_f32_16x16x32_bf16 v[40:43], v[144:147], v[132:135], v[40:43]
    ds_read_b64_tr_b16 v[104:105], v8 offset:36864
    s_waitcnt lgkmcnt(6)
    v_mfma_f32_16x16x32_bf16 v[16:19], v[192:195], v[168:171], v[16:19]
    ds_read_b64_tr_b16 v[106:107], v8 offset:37376
    v_mfma_f32_16x16x32_bf16 v[16:19], v[200:203], v[172:175], v[16:19]
    ds_read_b128 v[76:79], v5 offset:16640
    v_mfma_f32_16x16x32_bf16 v[16:19], v[208:211], v[176:179], v[16:19]
    ds_read_b64_tr_b16 v[112:113], v8 offset:45056
    v_mfma_f32_16x16x32_bf16 v[20:23], v[212:215], v[176:179], v[20:23]
    ds_read_b64_tr_b16 v[114:115], v8 offset:45568
    v_mfma_f32_16x16x32_bf16 v[20:23], v[204:207], v[172:175], v[20:23]
    ds_read_b128 v[80:83], v5 offset:25088
    v_mfma_f32_16x16x32_bf16 v[20:23], v[196:199], v[168:171], v[20:23]
    ds_read_b64_tr_b16 v[116:117], v9 offset:45056
    v_mfma_f32_16x16x32_bf16 v[28:31], v[196:199], v[172:175], v[28:31]
    ds_read_b64_tr_b16 v[118:119], v9 offset:45568
    v_mfma_f32_16x16x32_bf16 v[28:31], v[204:207], v[176:179], v[28:31]
    ds_read_b64_tr_b16 v[108:109], v9 offset:36864
    v_mfma_f32_16x16x32_bf16 v[28:31], v[212:215], v[180:183], v[28:31]
    ds_read_b64_tr_b16 v[110:111], v9 offset:37376
    v_mfma_f32_16x16x32_bf16 v[24:27], v[208:211], v[180:183], v[24:27]
    ds_read_b64_tr_b16 v[100:101], v9 offset:28672
    v_mfma_f32_16x16x32_bf16 v[24:27], v[200:203], v[176:179], v[24:27]
    ds_read_b64_tr_b16 v[102:103], v9 offset:29184
    v_mfma_f32_16x16x32_bf16 v[24:27], v[192:195], v[172:175], v[24:27]
L_loop:
    ds_read_b128 v[84:87], v5 offset:29184
    v_mfma_f32_16x16x32_bf16 v[32:35], v[192:195], v[176:179], v[32:35]
    ds_read_b128 v[88:91], v5 offset:20992
    v_mfma_f32_16x16x32_bf16 v[32:35], v[200:203], v[180:183], v[32:35]
    ds_read_b128 v[92:95], v7 offset:16640
    s_waitcnt lgkmcnt(6)
    v_mfma_f32_16x16x32_bf16 v[32:35], v[208:211], v[184:187], v[32:35]
    v_mfma_f32_16x16x32_bf16 v[36:39], v[212:215], v[184:187], v[36:39]
    v_mfma_f32_16x16x32_bf16 v[36:39], v[204:207], v[180:183], v[36:39]
    v_mfma_f32_16x16x32_bf16 v[36:39], v[196:199], v[176:179], v[36:39]
    v_mfma_f32_16x16x32_bf16 v[44:47], v[196:199], v[180:183], v[44:47]
    v_mfma_f32_16x16x32_bf16 v[44:47], v[204:207], v[184:187], v[44:47]
    s_waitcnt lgkmcnt(0)
    v_mfma_f32_16x16x32_bf16 v[44:47], v[212:215], v[188:191], v[44:47]
L_t1:
    s_cmp_eq_u32 s6, 1
    s_cbranch_scc1 L_cons
    s_barrier
    ds_read_b64_tr_b16 v[144:145], v10 offset:0
    v_mfma_f32_16x16x32_bf16 v[40:43], v[208:211], v[188:191], v[40:43]
    ds_read_b64_tr_b16 v[146:147], v10 offset:512
    v_mfma_f32_16x16x32_bf16 v[40:43], v[200:203], v[184:187], v[40:43]
    ds_read_b128 v[120:123], v2 offset:33280
    v_mfma_f32_16x16x32_bf16 v[40:43], v[192:195], v[180:183], v[40:43]
    ds_read_b64_tr_b16 v[152:153], v10 offset:8192
    v_mfma_f32_16x16x32_bf16 v[16:19], v[96:99], v[72:75], v[16:19]
    ds_read_b64_tr_b16 v[154:155], v10 offset:8704
    v_mfma_f32_16x16x32_bf16 v[16:19], v[104:107], v[76:79], v[16:19]
    ds_read_b128 v[124:127], v4 offset:33280
    v_mfma_f32_16x16x32_bf16 v[16:19], v[112:115], v[80:83], v[16:19]
    ds_read_b64_tr_b16 v[160:161], v10 offset:16384
    v_mfma_f32_16x16x32_bf16 v[20:23], v[116:119], v[80:83], v[20:23]
    ds_read_b64_tr_b16 v[162:163], v10 offset:16896
    v_mfma_f32_16x16x32_bf16 v[20:23], v[108:111], v[76:79], v[20:23]
    ds_read_b128 v[128:131], v4 offset:41728
    v_mfma_f32_16x16x32_bf16 v[20:23], v[100:103], v[72:75], v[20:23]
    ds_read_b64_tr_b16 v[164:165], v11 offset:16384
    v_mfma_f32_16x16x32_bf16 v[28:31], v[100:103], v[76:79], v[28:31]
    ds_read_b64_tr_b16 v[166:167], v11 offset:16896
    v_mfma_f32_16x16x32_bf16 v[28:31], v[108:111], v[80:83], v[28:31]
    ds_read_b64_tr_b16 v[156:157], v11 offset:8192
    v_mfma_f32_16x16x32_bf16 v[28:31], v[116:119], v[84:87], v[28:31]
    ds_read_b64_tr_b16 v[158:159], v11 offset:8704
    v_mfma_f32_16x16x32_bf16 v[24:27], v[112:115], v[84:87], v[24:27]
    ds_read_b64_tr_b16 v[148:149], v11 offset:0
    v_mfma_f32_16x16x32_bf16 v[24:27], v[104:107], v[80:83], v[24:27]
    ds_read_b64_tr_b16 v[150:151], v11 offset:512
    v_mfma_f32_16x16x32_bf16 v[24:27], v[96:99], v[76:79], v[24:27]
    v_mfma_f32_16x16x32_bf16 v[32:35], v[96:99], v[80:83], v[32:35]
    v_mfma_f32_16x16x32_bf16 v[32:35], v[104:107], v[84:87], v[32:35]
    ds_read_b128 v[132:135], v4 offset:45824
    v_mfma_f32_16x16x32_bf16 v[32:35], v[112:115], v[88:91], v[32:35]
    v_mfma_f32_16x16x32_bf16 v[36:39], v[116:119], v[88:91], v[36:39]
    v_mfma_f32_16x16x32_bf16 v[36:39], v[108:111], v[84:87], v[36:39]
    v_mfma_f32_16x16x32_bf16 v[36:39], v[100:103], v[80:83], v[36:39]
    v_mfma_f32_16x16x32_bf16 v[44:47], v[100:103], v[84:87], v[44:47]
    ds_read_b128 v[136:139], v4 offset:37632
    v_mfma_f32_16x16x32_bf16 v[44:47], v[108:111], v[88:91], v[44:47]
    ds_read_b128 v[140:143], v6 offset:33280
    v_mfma_f32_16x16x32_bf16 v[44:47], v[116:119], v[92:95], v[44:47]
    ds_read_b64_tr_b16 v[192:193], v10 offset:4096
    v_mfma_f32_16x16x32_bf16 v[40:43], v[112:115], v[92:95], v[40:43]
    ds_read_b64_tr_b16 v[194:195], v10 offset:4608
    v_mfma_f32_16x16x32_bf16 v[40:43], v[104:107], v[88:91], v[40:43]
    ds_read_b128 v[168:171], v3 offset:33280
    v_mfma_f32_16x16x32_bf16 v[40:43], v[96:99], v[84:87], v[40:43]
    ds_read_b64_tr_b16 v[200:201], v10 offset:12288
    s_waitcnt lgkmcnt(6)
    v_mfma_f32_16x16x32_bf16 v[16:19], v[144:147], v[120:123], v[16:19]
    ds_read_b64_tr_b16 v[202:203], v10 offset:12800
    v_mfma_f32_16x16x32_bf16 v[16:19], v[152:155], v[124:127], v[16:19]
    ds_read_b128 v[172:175], v5 offset:33280
    v_mfma_f32_16x16x32_bf16 v[16:19], v[160:163], v[128:131], v[16:19]
    ds_read_b64_tr_b16 v[208:209], v10 offset:20480
    v_mfma_f32_16x16x32_bf16 v[20:23], v[164:167], v[128:131], v[20:23]
    ds_read_b64_tr_b16 v[210:211], v10 offset:20992
    v_mfma_f32_16x16x32_bf16 v[20:23], v[156:159], v[124:127], v[20:23]
    ds_read_b128 v[176:179], v5 offset:41728
    v_mfma_f32_16x16x32_bf16 v[20:23], v[148:151], v[120:123], v[20:23]
    ds_read_b64_tr_b16 v[212:213], v11 offset:20480
    v_mfma_f32_16x16x32_bf16 v[28:31], v[148:151], v[124:127], v[28:31]
    ds_read_b64_tr_b16 v[214:215], v11 offset:20992
    v_mfma_f32_16x16x32_bf16 v[28:31], v[156:159], v[128:131], v[28:31]
    ds_read_b64_tr_b16 v[204:205], v11 offset:12288
    v_mfma_f32_16x16x32_bf16 v[28:31], v[164:167], v[132:135], v[28:31]
    ds_read_b64_tr_b16 v[206:207], v11 offset:12800
    v_mfma_f32_16x16x32_bf16 v[24:27], v[160:163], v[132:135], v[24:27]
    ds_read_b64_tr_b16 v[196:197], v11 offset:4096
    v_mfma_f32_16x16x32_bf16 v[24:27], v[152:155], v[128:131], v[24:27]
    ds_read_b64_tr_b16 v[198:199], v11 offset:4608
    v_mfma_f32_16x16x32_bf16 v[24:27], v[144:147], v[124:127], v[24:27]
    ds_read_b128 v[180:183], v5 offset:45824
    v_mfma_f32_16x16x32_bf16 v[32:35], v[144:147], v[128:131], v[32:35]
    ds_read_b128 v[184:187], v5 offset:37632
    v_mfma_f32_16x16x32_bf16 v[32:35], v[152:155], v[132:135], v[32:35]
    ds_read_b128 v[188:191], v7 offset:33280
    s_waitcnt lgkmcnt(6)
    v_mfma_f32_16x16x32_bf16 v[32:35], v[160:163], v[136:139], v[32:35]
    v_mfma_f32_16x16x32_bf16 v[36:39], v[164:167], v[136:139], v[36:39]
    v_mfma_f32_16x16x32_bf16 v[36:39], v[156:159], v[132:135], v[36:39]
    v_mfma_f32_16x16x32_bf16 v[36:39], v[148:151], v[128:131], v[36:39]
    v_mfma_f32_16x16x32_bf16 v[44:47], v[148:151], v[132:135], v[44:47]
    v_mfma_f32_16x16x32_bf16 v[44:47], v[156:159], v[136:139], v[44:47]
    s_waitcnt lgkmcnt(0)
    v_mfma_f32_16x16x32_bf16 v[44:47], v[164:167], v[140:143], v[44:47]
    s_barrier
    ds_read_b64_tr_b16 v[96:97], v8 offset:0
    v_mfma_f32_16x16x32_bf16 v[40:43], v[160:163], v[140:143], v[40:43]
    ds_read_b64_tr_b16 v[98:99], v8 offset:512
    v_mfma_f32_16x16x32_bf16 v[40:43], v[152:155], v[136:139], v[40:43]
    ds_read_b128 v[72:75], v2 offset:0
    v_mfma_f32_16x16x32_bf16 v[40:43], v[144:147], v[132:135], v[40:43]
    ds_read_b64_tr_b16 v[104:105], v8 offset:8192
    v_mfma_f32_16x16x32_bf16 v[16:19], v[192:195], v[168:171], v[16:19]
    ds_read_b64_tr_b16 v[106:107], v8 offset:8704
    v_mfma_f32_16x16x32_bf16 v[16:19], v[200:203], v[172:175], v[16:19]
    ds_read_b128 v[76:79], v4 offset:0
    v_mfma_f32_16x16x32_bf16 v[16:19], v[208:211], v[176:179], v[16:19]
    ds_read_b64_tr_b16 v[112:113], v8 offset:16384
    v_mfma_f32_16x16x32_bf16 v[20:23], v[212:215], v[176:179], v[20:23]
    ds_read_b64_tr_b16 v[114:115], v8 offset:16896
    v_mfma_f32_16x16x32_bf16 v[20:23], v[204:207], v[172:175], v[20:23]
    ds_read_b128 v[80:83], v4 offset:8448
    v_mfma_f32_16x16x32_bf16 v[20:23], v[196:199], v[168:171], v[20:23]
    ds_read_b64_tr_b16 v[116:117], v9 offset:16384
    v_mfma_f32_16x16x32_bf16 v[28:31], v[196:199], v[172:175], v[28:31]
    ds_read_b64_tr_b16 v[118:119], v9 offset:16896
    v_mfma_f32_16x16x32_bf16 v[28:31], v[204:207], v[176:179], v[28:31]
    ds_read_b64_tr_b16 v[108:109], v9 offset:8192
    v_mfma_f32_16x16x32_bf16 v[28:31], v[212:215], v[180:183], v[28:31]
    ds_read_b64_tr_b16 v[110:111], v9 offset:8704
    v_mfma_f32_16x16x32_bf16 v[24:27], v[208:211], v[180:183], v[24:27]
    ds_read_b64_tr_b16 v[100:101], v9 offset:0
    v_mfma_f32_16x16x32_bf16 v[24:27], v[200:203], v[176:179], v[24:27]
    ds_read_b64_tr_b16 v[102:103], v9 offset:512
    v_mfma_f32_16x16x32_bf16 v[24:27], v[192:195], v[172:175], v[24:27]
    v_mfma_f32_16x16x32_bf16 v[32:35], v[192:195], v[176:179], v[32:35]
    v_mfma_f32_16x16x32_bf16 v[32:35], v[200:203], v[180:183], v[32:35]
    ds_read_b128 v[84:87], v4 offset:12544
    v_mfma_f32_16x16x32_bf16 v[32:35], v[208:211], v[184:187], v[32:35]
    v_mfma_f32_16x16x32_bf16 v[36:39], v[212:215], v[184:187], v[36:39]
    v_mfma_f32_16x16x32_bf16 v[36:39], v[204:207], v[180:183], v[36:39]
    v_mfma_f32_16x16x32_bf16 v[36:39], v[196:199], v[176:179], v[36:39]
    v_mfma_f32_16x16x32_bf16 v[44:47], v[196:199], v[180:183], v[44:47]
    ds_read_b128 v[88:91], v4 offset:4352
    v_mfma_f32_16x16x32_bf16 v[44:47], v[204:207], v[184:187], v[44:47]
    ds_read_b128 v[92:95], v6 offset:0
    v_mfma_f32_16x16x32_bf16 v[44:47], v[212:215], v[188:191], v[44:47]
    ds_read_b64_tr_b16 v[144:145], v8 offset:4096
    v_mfma_f32_16x16x32_bf16 v[40:43], v[208:211], v[188:191], v[40:43]
    ds_read_b64_tr_b16 v[146:147], v8 offset:4608
    v_mfma_f32_16x16x32_bf16 v[40:43], v[200:203], v[184:187], v[40:43]
    ds_read_b128 v[120:123], v3 offset:0
    v_mfma_f32_16x16x32_bf16 v[40:43], v[192:195], v[180:183], v[40:43]
    ds_read_b64_tr_b16 v[152:153], v8 offset:12288
    s_waitcnt lgkmcnt(6)
    v_mfma_f32_16x16x32_bf16 v[16:19], v[96:99], v[72:75], v[16:19]
    ds_read_b64_tr_b16 v[154:155], v8 offset:12800
    v_mfma_f32_16x16x32_bf16 v[16:19], v[104:107], v[76:79], v[16:19]
    ds_read_b128 v[124:127], v5 offset:0
    v_mfma_f32_16x16x32_bf16 v[16:19], v[112:115], v[80:83], v[16:19]
    ds_read_b64_tr_b16 v[160:161], v8 offset:20480
    v_mfma_f32_16x16x32_bf16 v[20:23], v[116:119], v[80:83], v[20:23]
    ds_read_b64_tr_b16 v[162:163], v8 offset:20992
    v_mfma_f32_16x16x32_bf16 v[20:23], v[108:111], v[76:79], v[20:23]
    ds_read_b128 v[128:131], v5 offset:8448
    v_mfma_f32_16x16x32_bf16 v[20:23], v[100:103], v[72:75], v[20:23]
    ds_read_b64_tr_b16 v[164:165], v9 offset:20480
    v_mfma_f32_16x16x32_bf16 v[28:31], v[100:103], v[76:79], v[28:31]
    ds_read_b64_tr_b16 v[166:167], v9 offset:20992
    v_mfma_f32_16x16x32_bf16 v[28:31], v[108:111], v[80:83], v[28:31]
    ds_read_b64_tr_b16 v[156:157], v9 offset:12288
    v_mfma_f32_16x16x32_bf16 v[28:31], v[116:119], v[84:87], v[28:31]
    ds_read_b64_tr_b16 v[158:159], v9 offset:12800
    v_mfma_f32_16x16x32_bf16 v[24:27], v[112:115], v[84:87], v[24:27]
    ds_read_b64_tr_b16 v[148:149], v9 offset:4096
    v_mfma_f32_16x16x32_bf16 v[24:27], v[104:107], v[80:83], v[24:27]
    ds_read_b64_tr_b16 v[150:151], v9 offset:4608
    v_mfma_f32_16x16x32_bf16 v[24:27], v[96:99], v[76:79], v[24:27]
    ds_read_b128 v[132:135], v5 offset:12544
    v_mfma_f32_16x16x32_bf16 v[32:35], v[96:99], v[80:83], v[32:35]
    ds_read_b128 v[136:139], v5 offset:4352
    v_mfma_f32_16x16x32_bf16 v[32:35], v[104:107], v[84:87], v[32:35]
    ds_read_b128 v[140:143], v7 offset:0
    s_waitcnt lgkmcnt(6)
    v_mfma_f32_16x16x32_bf16 v[32:35], v[112:115], v[88:91], v[32:35]
    v_mfma_f32_16x16x32_bf16 v[36:39], v[116:119], v[88:91], v[36:39]
    v_mfma_f32_16x16x32_bf16 v[36:39], v[108:111], v[84:87], v[36:39]
    v_mfma_f32_16x16x32_bf16 v[36:39], v[100:103], v[80:83], v[36:39]
    v_mfma_f32_16x16x32_bf16 v[44:47], v[100:103], v[84:87], v[44:47]
    v_mfma_f32_16x16x32_bf16 v[44:47], v[108:111], v[88:91], v[44:47]
    s_waitcnt lgkmcnt(0)
    v_mfma_f32_16x16x32_bf16 v[44:47], v[116:119], v[92:95], v[44:47]
    s_barrier
    ds_read_b64_tr_b16 v[192:193], v8 offset:24576
    v_mfma_f32_16x16x32_bf16 v[40:43], v[112:115], v[92:95], v[40:43]
    ds_read_b64_tr_b16 v[194:195], v8 offset:25088
    v_mfma_f32_16x16x32_bf16 v[40:43], v[104:107], v[88:91], v[40:43]
    ds_read_b128 v[168:171], v2 offset:16640
    v_mfma_f32_16x16x32_bf16 v[40:43], v[96:99], v[84:87], v[40:43]
    ds_read_b64_tr_b16 v[200:201], v8 offset:32768
    v_mfma_f32_16x16x32_bf16 v[16:19], v[144:147], v[120:123], v[16:19]
    ds_read_b64_tr_b16 v[202:203], v8 offset:33280
    v_mfma_f32_16x16x32_bf16 v[16:19], v[152:155], v[124:127], v[16:19]
    ds_read_b128 v[172:175], v4 offset:16640
    v_mfma_f32_16x16x32_bf16 v[16:19], v[160:163], v[128:131], v[16:19]
    ds_read_b64_tr_b16 v[208:209], v8 offset:40960
    v_mfma_f32_16x16x32_bf16 v[20:23], v[164:167], v[128:131], v[20:23]
    ds_read_b64_tr_b16 v[210:211], v8 offset:41472
    v_mfma_f32_16x16x32_bf16 v[20:23], v[156:159], v[124:127], v[20:23]
    ds_read_b128 v[176:179], v4 offset:25088
    v_mfma_f32_16x16x32_bf16 v[20:23], v[148:151], v[120:123], v[20:23]
    ds_read_b64_tr_b16 v[212:213], v9 offset:40960
    v_mfma_f32_16x16x32_bf16 v[28:31], v[148:151], v[124:127], v[28:31]
    ds_read_b64_tr_b16 v[214:215], v9 offset:41472
    v_mfma_f32_16x16x32_bf16 v[28:31], v[156:159], v[128:131], v[28:31]
    ds_read_b64_tr_b16 v[204:205], v9 offset:32768
    v_mfma_f32_16x16x32_bf16 v[28:31], v[164:167], v[132:135], v[28:31]
    ds_read_b64_tr_b16 v[206:207], v9 offset:33280
    v_mfma_f32_16x16x32_bf16 v[24:27], v[160:163], v[132:135], v[24:27]
    ds_read_b64_tr_b16 v[196:197], v9 offset:24576
    v_mfma_f32_16x16x32_bf16 v[24:27], v[152:155], v[128:131], v[24:27]
    ds_read_b64_tr_b16 v[198:199], v9 offset:25088
    v_mfma_f32_16x16x32_bf16 v[24:27], v[144:147], v[124:127], v[24:27]
    v_mfma_f32_16x16x32_bf16 v[32:35], v[144:147], v[128:131], v[32:35]
    v_mfma_f32_16x16x32_bf16 v[32:35], v[152:155], v[132:135], v[32:35]
    ds_read_b128 v[180:183], v4 offset:29184
    v_mfma_f32_16x16x32_bf16 v[32:35], v[160:163], v[136:139], v[32:35]
    v_mfma_f32_16x16x32_bf16 v[36:39], v[164:167], v[136:139], v[36:39]
    v_mfma_f32_16x16x32_bf16 v[36:39], v[156:159], v[132:135], v[36:39]
    v_mfma_f32_16x16x32_bf16 v[36:39], v[148:151], v[128:131], v[36:39]
    s_sub_u32 s30, s30, 1
    s_cmp_lg_u32 s30, 0
    v_mfma_f32_16x16x32_bf16 v[44:47], v[148:151], v[132:135], v[44:47]
    ds_read_b128 v[184:187], v4 offset:20992
    v_mfma_f32_16x16x32_bf16 v[44:47], v[156:159], v[136:139], v[44:47]
    ds_read_b128 v[188:191], v6 offset:16640
    v_mfma_f32_16x16x32_bf16 v[44:47], v[164:167], v[140:143], v[44:47]
    ds_read_b64_tr_b16 v[96:97], v8 offset:28672
    v_mfma_f32_16x16x32_bf16 v[40:43], v[160:163], v[140:143], v[40:43]
    ds_read_b64_tr_b16 v[98:99], v8 offset:29184
    v_mfma_f32_16x16x32_bf16 v[40:43], v[152:155], v[136:139], v[40:43]
    ds_read_b128 v[72:75], v3 offset:16640
    v_mfma_f32_16x16x32_bf16 v[40:43], v[144:147], v[132:135], v[40:43]
    ds_read_b64_tr_b16 v[104:105], v8 offset:36864
    s_waitcnt lgkmcnt(6)
    v_mfma_f32_16x16x32_bf16 v[16:19], v[192:195], v[168:171], v[16:19]
    ds_read_b64_tr_b16 v[106:107], v8 offset:37376
    v_mfma_f32_16x16x32_bf16 v[16:19], v[200:203], v[172:175], v[16:19]
    ds_read_b128 v[76:79], v5 offset:16640
    v_mfma_f32_16x16x32_bf16 v[16:19], v[208:211], v[176:179], v[16:19]
    ds_read_b64_tr_b16 v[112:113], v8 offset:45056
    v_mfma_f32_16x16x32_bf16 v[20:23], v[212:215], v[176:179], v[20:23]
    ds_read_b64_tr_b16 v[114:115], v8 offset:45568
    v_mfma_f32_16x16x32_bf16 v[20:23], v[204:207], v[172:175], v[20:23]
    ds_read_b128 v[80:83], v5 offset:25088
    v_mfma_f32_16x16x32_bf16 v[20:23], v[196:199], v[168:171], v[20:23]
    ds_read_b64_tr_b16 v[116:117], v9 offset:45056
    v_mfma_f32_16x16x32_bf16 v[28:31], v[196:199], v[172:175], v[28:31]
    ds_read_b64_tr_b16 v[118:119], v9 offset:45568
    v_mfma_f32_16x16x32_bf16 v[28:31], v[204:207], v[176:179], v[28:31]
    ds_read_b64_tr_b16 v[108:109], v9 offset:36864
    v_mfma_f32_16x16x32_bf16 v[28:31], v[212:215], v[180:183], v[28:31]
    ds_read_b64_tr_b16 v[110:111], v9 offset:37376
    v_mfma_f32_16x16x32_bf16 v[24:27], v[208:211], v[180:183], v[24:27]
    ds_read_b64_tr_b16 v[100:101], v9 offset:28672
    v_mfma_f32_16x16x32_bf16 v[24:27], v[200:203], v[176:179], v[24:27]
    ds_read_b64_tr_b16 v[102:103], v9 offset:29184
    v_mfma_f32_16x16x32_bf16 v[24:27], v[192:195], v[172:175], v[24:27]
    s_cbranch_scc1 L_loop
    v_mfma_f32_16x16x32_bf16 v[32:35], v[192:195], v[176:179], v[32:35]
    v_mfma_f32_16x16x32_bf16 v[32:35], v[200:203], v[180:183], v[32:35]
    ds_read_b128 v[84:87], v5 offset:29184
    s_waitcnt lgkmcnt(4)
    v_mfma_f32_16x16x32_bf16 v[32:35], v[208:211], v[184:187], v[32:35]
    v_mfma_f32_16x16x32_bf16 v[36:39], v[212:215], v[184:187], v[36:39]
    v_mfma_f32_16x16x32_bf16 v[36:39], v[204:207], v[180:183], v[36:39]
    v_mfma_f32_16x16x32_bf16 v[36:39], v[196:199], v[176:179], v[36:39]
    v_mfma_f32_16x16x32_bf16 v[44:47], v[196:199], v[180:183], v[44:47]
    ds_read_b128 v[88:91], v5 offset:20992
    v_mfma_f32_16x16x32_bf16 v[44:47], v[204:207], v[184:187], v[44:47]
    ds_read_b128 v[92:95], v7 offset:16640
    v_mfma_f32_16x16x32_bf16 v[44:47], v[212:215], v[188:191], v[44:47]
    s_barrier
    ds_read_b64_tr_b16 v[144:145], v10 offset:0
    v_mfma_f32_16x16x32_bf16 v[40:43], v[208:211], v[188:191], v[40:43]
    ds_read_b64_tr_b16 v[146:147], v10 offset:512
    v_mfma_f32_16x16x32_bf16 v[40:43], v[200:203], v[184:187], v[40:43]
    ds_read_b128 v[120:123], v2 offset:33280
    v_mfma_f32_16x16x32_bf16 v[40:43], v[192:195], v[180:183], v[40:43]
    ds_read_b64_tr_b16 v[152:153], v10 offset:8192
    v_mfma_f32_16x16x32_bf16 v[16:19], v[96:99], v[72:75], v[16:19]
    ds_read_b64_tr_b16 v[154:155], v10 offset:8704
    v_mfma_f32_16x16x32_bf16 v[16:19], v[104:107], v[76:79], v[16:19]
    ds_read_b128 v[124:127], v4 offset:33280
    v_mfma_f32_16x16x32_bf16 v[16:19], v[112:115], v[80:83], v[16:19]
    ds_read_b64_tr_b16 v[160:161], v10 offset:16384
    v_mfma_f32_16x16x32_bf16 v[20:23], v[116:119], v[80:83], v[20:23]
    ds_read_b64_tr_b16 v[162:163], v10 offset:16896
    s_waitcnt lgkmcnt(6)
    v_mfma_f32_16x16x32_bf16 v[20:23], v[108:111], v[76:79], v[20:23]
    ds_read_b128 v[128:131], v4 offset:41728
    v_mfma_f32_16x16x32_bf16 v[20:23], v[100:103], v[72:75], v[20:23]
    ds_read_b64_tr_b16 v[164:165], v11 offset:16384
    v_mfma_f32_16x16x32_bf16 v[28:31], v[100:103], v[76:79], v[28:31]
    ds_read_b64_tr_b16 v[166:167], v11 offset:16896
    v_mfma_f32_16x16x32_bf16 v[28:31], v[108:111], v[80:83], v[28:31]
    ds_read_b64_tr_b16 v[156:157], v11 offset:8192
    v_mfma_f32_16x16x32_bf16 v[28:31], v[116:119], v[84:87], v[28:31]
    ds_read_b64_tr_b16 v[158:159], v11 offset:8704
    v_mfma_f32_16x16x32_bf16 v[24:27], v[112:115], v[84:87], v[24:27]
    ds_read_b64_tr_b16 v[148:149], v11 offset:0
    v_mfma_f32_16x16x32_bf16 v[24:27], v[104:107], v[80:83], v[24:27]
    ds_read_b64_tr_b16 v[150:151], v11 offset:512
    v_mfma_f32_16x16x32_bf16 v[24:27], v[96:99], v[76:79], v[24:27]
    ds_read_b128 v[132:135], v4 offset:45824
    v_mfma_f32_16x16x32_bf16 v[32:35], v[96:99], v[80:83], v[32:35]
    ds_read_b128 v[136:139], v4 offset:37632
    v_mfma_f32_16x16x32_bf16 v[32:35], v[104:107], v[84:87], v[32:35]
    ds_read_b128 v[140:143], v6 offset:33280
    v_mfma_f32_16x16x32_bf16 v[32:35], v[112:115], v[88:91], v[32:35]
    ds_read_b64_tr_b16 v[192:193], v10 offset:4096
    v_mfma_f32_16x16x32_bf16 v[36:39], v[116:119], v[88:91], v[36:39]
    ds_read_b64_tr_b16 v[194:195], v10 offset:4608
    v_mfma_f32_16x16x32_bf16 v[36:39], v[108:111], v[84:87], v[36:39]
    ds_read_b128 v[168:171], v3 offset:33280
    v_mfma_f32_16x16x32_bf16 v[36:39], v[100:103], v[80:83], v[36:39]
    ds_read_b64_tr_b16 v[200:201], v10 offset:12288
    v_mfma_f32_16x16x32_bf16 v[44:47], v[100:103], v[84:87], v[44:47]
    ds_read_b64_tr_b16 v[202:203], v10 offset:12800
    v_mfma_f32_16x16x32_bf16 v[44:47], v[108:111], v[88:91], v[44:47]
    ds_read_b128 v[172:175], v5 offset:33280
    v_mfma_f32_16x16x32_bf16 v[44:47], v[116:119], v[92:95], v[44:47]
    ds_read_b64_tr_b16 v[208:209], v10 offset:20480
    v_mfma_f32_16x16x32_bf16 v[40:43], v[112:115], v[92:95], v[40:43]
    ds_read_b64_tr_b16 v[210:211], v10 offset:20992
    v_mfma_f32_16x16x32_bf16 v[40:43], v[104:107], v[88:91], v[40:43]
    ds_read_b128 v[176:179], v5 offset:41728
    v_mfma_f32_16x16x32_bf16 v[40:43], v[96:99], v[84:87], v[40:43]
    ds_read_b64_tr_b16 v[212:213], v11 offset:20480
    s_waitcnt lgkmcnt(6)
    v_mfma_f32_16x16x32_bf16 v[16:19], v[144:147], v[120:123], v[16:19]
    ds_read_b64_tr_b16 v[214:215], v11 offset:20992
    v_mfma_f32_16x16x32_bf16 v[16:19], v[152:155], v[124:127], v[16:19]
    ds_read_b64_tr_b16 v[204:205], v11 offset:12288
    v_mfma_f32_16x16x32_bf16 v[16:19], v[160:163], v[128:131], v[16:19]
    ds_read_b64_tr_b16 v[206:207], v11 offset:12800
    v_mfma_f32_16x16x32_bf16 v[20:23], v[164:167], v[128:131], v[20:23]
    ds_read_b64_tr_b16 v[196:197], v11 offset:4096
    v_mfma_f32_16x16x32_bf16 v[20:23], v[156:159], v[124:127], v[20:23]
    ds_read_b64_tr_b16 v[198:199], v11 offset:4608
    v_mfma_f32_16x16x32_bf16 v[20:23], v[148:151], v[120:123], v[20:23]
    s_barrier
    ds_read_b64_tr_b16 v[100:101], v9 offset:0
    v_mfma_f32_16x16x32_bf16 v[28:31], v[148:151], v[124:127], v[28:31]
    ds_read_b64_tr_b16 v[102:103], v9 offset:512
    v_mfma_f32_16x16x32_bf16 v[28:31], v[156:159], v[128:131], v[28:31]
    ds_read_b128 v[72:75], v2 offset:0
    v_mfma_f32_16x16x32_bf16 v[28:31], v[164:167], v[132:135], v[28:31]
    ds_read_b64_tr_b16 v[108:109], v9 offset:8192
    v_mfma_f32_16x16x32_bf16 v[24:27], v[160:163], v[132:135], v[24:27]
    ds_read_b64_tr_b16 v[110:111], v9 offset:8704
    v_mfma_f32_16x16x32_bf16 v[24:27], v[152:155], v[128:131], v[24:27]
    ds_read_b128 v[76:79], v4 offset:0
    v_mfma_f32_16x16x32_bf16 v[24:27], v[144:147], v[124:127], v[24:27]
    ds_read_b64_tr_b16 v[116:117], v9 offset:16384
    v_mfma_f32_16x16x32_bf16 v[32:35], v[144:147], v[128:131], v[32:35]
    ds_read_b64_tr_b16 v[118:119], v9 offset:16896
    v_mfma_f32_16x16x32_bf16 v[32:35], v[152:155], v[132:135], v[32:35]
    ds_read_b128 v[80:83], v4 offset:8448
    v_mfma_f32_16x16x32_bf16 v[32:35], v[160:163], v[136:139], v[32:35]
    s_barrier
    ds_read_b64_tr_b16 v[188:189], v9 offset:4096
    v_mfma_f32_16x16x32_bf16 v[36:39], v[164:167], v[136:139], v[36:39]
    ds_read_b64_tr_b16 v[190:191], v9 offset:4608
    v_mfma_f32_16x16x32_bf16 v[36:39], v[156:159], v[132:135], v[36:39]
    ds_read_b128 v[120:123], v3 offset:0
    v_mfma_f32_16x16x32_bf16 v[36:39], v[148:151], v[128:131], v[36:39]
    ds_read_b64_tr_b16 v[184:185], v9 offset:12288
    v_mfma_f32_16x16x32_bf16 v[44:47], v[148:151], v[132:135], v[44:47]
    ds_read_b64_tr_b16 v[186:187], v9 offset:12800
    v_mfma_f32_16x16x32_bf16 v[44:47], v[156:159], v[136:139], v[44:47]
    ds_read_b128 v[124:127], v5 offset:0
    v_mfma_f32_16x16x32_bf16 v[44:47], v[164:167], v[140:143], v[44:47]
    ds_read_b64_tr_b16 v[180:181], v9 offset:20480
    v_mfma_f32_16x16x32_bf16 v[40:43], v[160:163], v[140:143], v[40:43]
    ds_read_b64_tr_b16 v[182:183], v9 offset:20992
    v_mfma_f32_16x16x32_bf16 v[40:43], v[152:155], v[136:139], v[40:43]
    ds_read_b128 v[128:131], v5 offset:8448
    v_mfma_f32_16x16x32_bf16 v[40:43], v[144:147], v[132:135], v[40:43]
    ds_read_b64_tr_b16 v[160:161], v8 offset:20480
    v_mfma_f32_16x16x32_bf16 v[16:19], v[192:195], v[168:171], v[16:19]
    ds_read_b64_tr_b16 v[162:163], v8 offset:20992
    s_waitcnt lgkmcnt(6)
    v_mfma_f32_16x16x32_bf16 v[16:19], v[200:203], v[172:175], v[16:19]
    ds_read_b64_tr_b16 v[152:153], v8 offset:12288
    v_mfma_f32_16x16x32_bf16 v[16:19], v[208:211], v[176:179], v[16:19]
    ds_read_b64_tr_b16 v[154:155], v8 offset:12800
    v_mfma_f32_16x16x32_bf16 v[20:23], v[212:215], v[176:179], v[20:23]
    ds_read_b64_tr_b16 v[144:145], v8 offset:4096
    v_mfma_f32_16x16x32_bf16 v[20:23], v[204:207], v[172:175], v[20:23]
    ds_read_b64_tr_b16 v[146:147], v8 offset:4608
    v_mfma_f32_16x16x32_bf16 v[20:23], v[196:199], v[168:171], v[20:23]
    ds_read_b64_tr_b16 v[96:97], v8 offset:0
    v_mfma_f32_16x16x32_bf16 v[20:23], v[100:103], v[72:75], v[20:23]
    ds_read_b64_tr_b16 v[98:99], v8 offset:512
    v_mfma_f32_16x16x32_bf16 v[20:23], v[108:111], v[76:79], v[20:23]
    ds_read_b64_tr_b16 v[104:105], v8 offset:8192
    v_mfma_f32_16x16x32_bf16 v[20:23], v[116:119], v[80:83], v[20:23]
    ds_read_b64_tr_b16 v[106:107], v8 offset:8704
    v_mfma_f32_16x16x32_bf16 v[20:23], v[188:191], v[120:123], v[20:23]
    ds_read_b64_tr_b16 v[112:113], v8 offset:16384
    s_waitcnt lgkmcnt(6)
    v_mfma_f32_16x16x32_bf16 v[20:23], v[184:187], v[124:127], v[20:23]
    ds_read_b64_tr_b16 v[114:115], v8 offset:16896
    v_mfma_f32_16x16x32_bf16 v[20:23], v[180:183], v[128:131], v[20:23]
    v_mfma_f32_16x16x32_bf16 v[16:19], v[160:163], v[128:131], v[16:19]
    v_mfma_f32_16x16x32_bf16 v[16:19], v[152:155], v[124:127], v[16:19]
    ds_read_b128 v[92:95], v5 offset:45824
    s_waitcnt lgkmcnt(4)
    v_mfma_f32_16x16x32_bf16 v[16:19], v[144:147], v[120:123], v[16:19]
    v_mfma_f32_16x16x32_bf16 v[16:19], v[96:99], v[72:75], v[16:19]
    s_waitcnt lgkmcnt(2)
    v_mfma_f32_16x16x32_bf16 v[16:19], v[104:107], v[76:79], v[16:19]
    ds_read_b128 v[84:87], v4 offset:12544
    s_waitcnt lgkmcnt(2)
    v_mfma_f32_16x16x32_bf16 v[16:19], v[112:115], v[80:83], v[16:19]
    v_fma_f32 v20, v20, v52, v60
    v_fma_f32 v21, v21, v53, v61
    v_mfma_f32_16x16x32_bf16 v[24:27], v[192:195], v[172:175], v[24:27]
    v_fma_f32 v22, v22, v54, v62
    v_fma_f32 v23, v23, v55, v63
    v_mfma_f32_16x16x32_bf16 v[24:27], v[200:203], v[176:179], v[24:27]
    ds_read_b128 v[132:135], v5 offset:12544
    s_waitcnt lgkmcnt(2)
    v_mfma_f32_16x16x32_bf16 v[24:27], v[208:211], v[92:95], v[24:27]
    v_exp_f32 v64, v20
    v_mfma_f32_16x16x32_bf16 v[24:27], v[96:99], v[76:79], v[24:27]
    v_exp_f32 v65, v21
    v_mfma_f32_16x16x32_bf16 v[24:27], v[104:107], v[80:83], v[24:27]
    s_waitcnt lgkmcnt(1)
    v_exp_f32 v66, v22
    v_mfma_f32_16x16x32_bf16 v[24:27], v[112:115], v[84:87], v[24:27]
    v_exp_f32 v67, v23
    v_mfma_f32_16x16x32_bf16 v[24:27], v[144:147], v[124:127], v[24:27]
    v_fma_f32 v64, v64, s59, s59
    v_fma_f32 v65, v65, s59, s59
    v_mfma_f32_16x16x32_bf16 v[24:27], v[152:155], v[128:131], v[24:27]
    s_waitcnt lgkmcnt(0)
    v_fma_f32 v66, v66, s59, s59
    v_fma_f32 v67, v67, s59, s59
    v_mfma_f32_16x16x32_bf16 v[24:27], v[160:163], v[132:135], v[24:27]
    v_rcp_f32 v64, v64
    v_mfma_f32_16x16x32_bf16 v[28:31], v[180:183], v[132:135], v[28:31]
    v_rcp_f32 v65, v65
    v_mfma_f32_16x16x32_bf16 v[28:31], v[184:187], v[128:131], v[28:31]
    v_rcp_f32 v66, v66
    v_mfma_f32_16x16x32_bf16 v[28:31], v[188:191], v[124:127], v[28:31]
    ds_read_b128 v[88:91], v5 offset:37632
    v_mfma_f32_16x16x32_bf16 v[28:31], v[100:103], v[76:79], v[28:31]
    v_rcp_f32 v67, v67
    v_mfma_f32_16x16x32_bf16 v[28:31], v[108:111], v[80:83], v[28:31]
    v_mul_f32 v20, v20, v64
    v_mul_f32 v21, v21, v65
    v_mfma_f32_16x16x32_bf16 v[28:31], v[116:119], v[84:87], v[28:31]
    v_mul_f32 v22, v22, v66
    v_mul_f32 v23, v23, v67
    v_mfma_f32_16x16x32_bf16 v[28:31], v[196:199], v[172:175], v[28:31]
    v_cvt_pk_bf16_f32 v70, v20, v21
    v_cvt_pk_bf16_f32 v71, v22, v23
    v_mfma_f32_16x16x32_bf16 v[28:31], v[204:207], v[176:179], v[28:31]
    ds_read_b128 v[148:151], v4 offset:4352
    v_fma_f32 v16, v16, v48, v56
    v_mfma_f32_16x16x32_bf16 v[28:31], v[212:215], v[92:95], v[28:31]
    s_waitcnt lgkmcnt(1)
    v_fma_f32 v17, v17, v49, v57
    v_fma_f32 v18, v18, v50, v58
    v_mfma_f32_16x16x32_bf16 v[36:39], v[212:215], v[88:91], v[36:39]
    v_fma_f32 v19, v19, v51, v59
    v_mfma_f32_16x16x32_bf16 v[36:39], v[204:207], v[92:95], v[36:39]
    ds_read_b128 v[136:139], v5 offset:4352
    v_mfma_f32_16x16x32_bf16 v[36:39], v[196:199], v[176:179], v[36:39]
    v_exp_f32 v64, v16
    v_mfma_f32_16x16x32_bf16 v[36:39], v[100:103], v[80:83], v[36:39]
    v_exp_f32 v65, v17
    v_mfma_f32_16x16x32_bf16 v[36:39], v[108:111], v[84:87], v[36:39]
    s_waitcnt lgkmcnt(1)
    v_exp_f32 v66, v18
    v_mfma_f32_16x16x32_bf16 v[36:39], v[116:119], v[148:151], v[36:39]
    v_exp_f32 v67, v19
    v_mfma_f32_16x16x32_bf16 v[36:39], v[188:191], v[128:131], v[36:39]
    v_fma_f32 v64, v64, s59, s59
    v_fma_f32 v65, v65, s59, s59
    v_mfma_f32_16x16x32_bf16 v[36:39], v[184:187], v[132:135], v[36:39]
    s_waitcnt lgkmcnt(0)
    v_fma_f32 v66, v66, s59, s59
    v_fma_f32 v67, v67, s59, s59
    v_mfma_f32_16x16x32_bf16 v[36:39], v[180:183], v[136:139], v[36:39]
    v_rcp_f32 v64, v64
    v_mfma_f32_16x16x32_bf16 v[32:35], v[160:163], v[136:139], v[32:35]
    v_rcp_f32 v65, v65
    v_mfma_f32_16x16x32_bf16 v[32:35], v[152:155], v[132:135], v[32:35]
    v_rcp_f32 v66, v66
    v_mfma_f32_16x16x32_bf16 v[32:35], v[144:147], v[128:131], v[32:35]
    ds_read_b128 v[156:159], v7 offset:33280
    v_mfma_f32_16x16x32_bf16 v[32:35], v[96:99], v[80:83], v[32:35]
    v_rcp_f32 v67, v67
    v_mfma_f32_16x16x32_bf16 v[32:35], v[104:107], v[84:87], v[32:35]
    v_mul_f32 v16, v16, v64
    v_mul_f32 v17, v17, v65
    v_mfma_f32_16x16x32_bf16 v[32:35], v[112:115], v[148:151], v[32:35]
    v_mul_f32 v18, v18, v66
    v_mul_f32 v19, v19, v67
    v_mfma_f32_16x16x32_bf16 v[32:35], v[192:195], v[176:179], v[32:35]
    v_cvt_pk_bf16_f32 v68, v16, v17
    v_cvt_pk_bf16_f32 v69, v18, v19
    v_mfma_f32_16x16x32_bf16 v[32:35], v[200:203], v[92:95], v[32:35]
    ds_read_b128 v[164:167], v6 offset:0
    v_permlane16_swap_b32 v68, v70
    v_mfma_f32_16x16x32_bf16 v[32:35], v[208:211], v[88:91], v[32:35]
    s_waitcnt lgkmcnt(1)
    v_permlane16_swap_b32 v69, v71
    v_mfma_f32_16x16x32_bf16 v[40:43], v[208:211], v[156:159], v[40:43]
    buffer_store_dwordx4 v[68:71], v12, s[16:19], 0 offen offset:0 sc0 sc1
    v_fma_f32 v24, v24, v48, v56
    v_mfma_f32_16x16x32_bf16 v[40:43], v[200:203], v[88:91], v[40:43]
    ds_read_b128 v[140:143], v7 offset:0
    v_fma_f32 v25, v25, v49, v57
    v_mfma_f32_16x16x32_bf16 v[40:43], v[192:195], v[92:95], v[40:43]
    v_fma_f32 v26, v26, v50, v58
    v_fma_f32 v27, v27, v51, v59
    v_mfma_f32_16x16x32_bf16 v[40:43], v[96:99], v[84:87], v[40:43]
    v_exp_f32 v64, v24
    v_mfma_f32_16x16x32_bf16 v[40:43], v[104:107], v[148:151], v[40:43]
    s_waitcnt lgkmcnt(1)
    v_exp_f32 v65, v25
    v_mfma_f32_16x16x32_bf16 v[40:43], v[112:115], v[164:167], v[40:43]
    v_exp_f32 v66, v26
    v_mfma_f32_16x16x32_bf16 v[40:43], v[144:147], v[132:135], v[40:43]
    v_exp_f32 v67, v27
    v_mfma_f32_16x16x32_bf16 v[40:43], v[152:155], v[136:139], v[40:43]
    s_waitcnt lgkmcnt(0)
    v_fma_f32 v64, v64, s59, s59
    v_fma_f32 v65, v65, s59, s59
    v_mfma_f32_16x16x32_bf16 v[40:43], v[160:163], v[140:143], v[40:43]
    v_fma_f32 v66, v66, s59, s59
    v_fma_f32 v67, v67, s59, s59
    v_mfma_f32_16x16x32_bf16 v[44:47], v[180:183], v[140:143], v[44:47]
    v_rcp_f32 v64, v64
    v_mfma_f32_16x16x32_bf16 v[44:47], v[184:187], v[136:139], v[44:47]
    v_rcp_f32 v65, v65
    v_mfma_f32_16x16x32_bf16 v[44:47], v[188:191], v[132:135], v[44:47]
    v_rcp_f32 v66, v66
    v_mfma_f32_16x16x32_bf16 v[44:47], v[100:103], v[84:87], v[44:47]
    v_rcp_f32 v67, v67
    v_mfma_f32_16x16x32_bf16 v[44:47], v[108:111], v[148:151], v[44:47]
    v_mul_f32 v24, v24, v64
    v_mul_f32 v25, v25, v65
    v_mfma_f32_16x16x32_bf16 v[44:47], v[116:119], v[164:167], v[44:47]
    v_mul_f32 v26, v26, v66
    v_mul_f32 v27, v27, v67
    v_mfma_f32_16x16x32_bf16 v[44:47], v[196:199], v[92:95], v[44:47]
    v_cvt_pk_bf16_f32 v68, v24, v25
    v_cvt_pk_bf16_f32 v69, v26, v27
L_t2:
    s_cmp_eq_u32 s6, 1
    s_cbranch_scc1 L_cons
    v_mfma_f32_16x16x32_bf16 v[44:47], v[204:207], v[88:91], v[44:47]
    v_fma_f32 v28, v28, v52, v60
    v_fma_f32 v29, v29, v53, v61
    v_mfma_f32_16x16x32_bf16 v[44:47], v[212:215], v[156:159], v[44:47]
    v_pk_fma_f32 v[30:31], v[30:31], v[54:55], v[62:63]
    v_exp_f32 v64, v28
    v_exp_f32 v65, v29
    v_exp_f32 v66, v30
    v_exp_f32 v67, v31
    v_pk_fma_f32 v[64:65], v[64:65], s[58:59], s[58:59] op_sel:[0,1,1] op_sel_hi:[1,1,1]
    v_pk_fma_f32 v[36:37], v[36:37], v[52:53], v[60:61]
    v_pk_fma_f32 v[66:67], v[66:67], s[58:59], s[58:59] op_sel:[0,1,1] op_sel_hi:[1,1,1]
    v_rcp_f32 v64, v64
    v_rcp_f32 v65, v65
    v_rcp_f32 v66, v66
    v_rcp_f32 v67, v67
    v_pk_mul_f32 v[28:29], v[28:29], v[64:65]
    v_pk_fma_f32 v[38:39], v[38:39], v[54:55], v[62:63]
    v_pk_mul_f32 v[30:31], v[30:31], v[66:67]
    v_cvt_pk_bf16_f32 v70, v28, v29
    v_exp_f32 v72, v36
    v_cvt_pk_bf16_f32 v71, v30, v31
    v_permlane16_swap_b32 v68, v70
    v_exp_f32 v73, v37
    v_permlane16_swap_b32 v69, v71
    v_exp_f32 v74, v38
    v_exp_f32 v75, v39
    buffer_store_dwordx4 v[68:71], v12, s[16:19], 0 offen offset:2048 sc0 sc1
    v_pk_fma_f32 v[72:73], v[72:73], s[58:59], s[58:59] op_sel:[0,1,1] op_sel_hi:[1,1,1]
    v_pk_fma_f32 v[74:75], v[74:75], s[58:59], s[58:59] op_sel:[0,1,1] op_sel_hi:[1,1,1]
    v_pk_fma_f32 v[32:33], v[32:33], v[48:49], v[56:57]
    v_rcp_f32 v72, v72
    v_rcp_f32 v73, v73
    v_rcp_f32 v74, v74
    v_rcp_f32 v75, v75
    v_pk_mul_f32 v[36:37], v[36:37], v[72:73]
    v_pk_fma_f32 v[34:35], v[34:35], v[50:51], v[58:59]
    v_pk_mul_f32 v[38:39], v[38:39], v[74:75]
    v_cvt_pk_bf16_f32 v78, v36, v37
    v_exp_f32 v80, v32
    v_cvt_pk_bf16_f32 v79, v38, v39
    v_exp_f32 v81, v33
    v_exp_f32 v82, v34
    v_exp_f32 v83, v35
    v_pk_fma_f32 v[80:81], v[80:81], s[58:59], s[58:59] op_sel:[0,1,1] op_sel_hi:[1,1,1]
    v_pk_fma_f32 v[40:41], v[40:41], v[48:49], v[56:57]
    v_pk_fma_f32 v[82:83], v[82:83], s[58:59], s[58:59] op_sel:[0,1,1] op_sel_hi:[1,1,1]
    v_rcp_f32 v80, v80
    v_rcp_f32 v81, v81
    v_rcp_f32 v82, v82
    v_rcp_f32 v83, v83
    v_pk_mul_f32 v[32:33], v[32:33], v[80:81]
    v_pk_fma_f32 v[42:43], v[42:43], v[50:51], v[58:59]
    v_pk_mul_f32 v[34:35], v[34:35], v[82:83]
    v_cvt_pk_bf16_f32 v76, v32, v33
    v_exp_f32 v84, v40
    v_cvt_pk_bf16_f32 v77, v34, v35
    v_permlane16_swap_b32 v76, v78
    v_exp_f32 v85, v41
    v_permlane16_swap_b32 v77, v79
    v_exp_f32 v86, v42
    v_exp_f32 v87, v43
    buffer_store_dwordx4 v[76:79], v12, s[16:19], s58 offen offset:0 sc0 sc1
    v_pk_fma_f32 v[84:85], v[84:85], s[58:59], s[58:59] op_sel:[0,1,1] op_sel_hi:[1,1,1]
    v_pk_fma_f32 v[86:87], v[86:87], s[58:59], s[58:59] op_sel:[0,1,1] op_sel_hi:[1,1,1]
    v_pk_fma_f32 v[44:45], v[44:45], v[52:53], v[60:61]
    v_rcp_f32 v84, v84
    v_rcp_f32 v85, v85
    v_rcp_f32 v86, v86
    v_rcp_f32 v87, v87
    v_pk_mul_f32 v[40:41], v[40:41], v[84:85]
    v_pk_fma_f32 v[46:47], v[46:47], v[54:55], v[62:63]
    v_pk_mul_f32 v[42:43], v[42:43], v[86:87]
    v_cvt_pk_bf16_f32 v92, v40, v41
    v_exp_f32 v96, v44
    v_cvt_pk_bf16_f32 v93, v42, v43
    v_exp_f32 v97, v45
    v_exp_f32 v98, v46
    v_exp_f32 v99, v47
    v_pk_fma_f32 v[96:97], v[96:97], s[58:59], s[58:59] op_sel:[0,1,1] op_sel_hi:[1,1,1]
    s_mov_b64 vcc, s[8:9]
    v_pk_fma_f32 v[98:99], v[98:99], s[58:59], s[58:59] op_sel:[0,1,1] op_sel_hi:[1,1,1]
    v_rcp_f32 v96, v96
    v_rcp_f32 v97, v97
    v_rcp_f32 v98, v98
    v_rcp_f32 v99, v99
    v_pk_mul_f32 v[44:45], v[44:45], v[96:97]
    v_pk_mul_f32 v[46:47], v[46:47], v[98:99]
    v_cvt_pk_bf16_f32 v94, v44, v45
    v_cvt_pk_bf16_f32 v95, v46, v47
    s_nop 0
    v_cndmask_b32_dpp v96, v94, v92, vcc quad_perm:[1,0,3,2] row_mask:0xf bank_mask:0xf
    v_cndmask_b32_dpp v97, v95, v93, vcc quad_perm:[1,0,3,2] row_mask:0xf bank_mask:0xf
    s_not_b64 vcc, vcc
    v_cndmask_b32_dpp v94, v92, v94, vcc quad_perm:[1,0,3,2] row_mask:0xf bank_mask:0xf
    v_cndmask_b32_dpp v95, v93, v95, vcc quad_perm:[1,0,3,2] row_mask:0xf bank_mask:0xf
    s_mov_b64 vcc, s[10:11]
    v_permlane32_swap_b32 v96, v94
    v_permlane32_swap_b32 v97, v95
    s_nop 0
    v_cndmask_b32_dpp v92, v94, v96, vcc quad_perm:[2,3,0,1] row_mask:0xf bank_mask:0xf
    v_cndmask_b32_dpp v93, v95, v97, vcc quad_perm:[2,3,0,1] row_mask:0xf bank_mask:0xf
    s_not_b64 vcc, vcc
    v_cndmask_b32_dpp v94, v96, v94, vcc quad_perm:[2,3,0,1] row_mask:0xf bank_mask:0xf
    v_cndmask_b32_dpp v95, v97, v95, vcc quad_perm:[2,3,0,1] row_mask:0xf bank_mask:0xf
    s_nop 0
    v_permlane16_swap_b32 v92, v94
    v_permlane16_swap_b32 v93, v95
    buffer_store_dwordx4 v[92:95], v14, s[16:19], s58 offen offset:2048 sc0 sc1
L_fin:
L_end:
    s_endpgm
.section .rodata,"a"
.p2align 6
.amdhsa_kernel standalone__batchnorm__prompt_kernel
.amdhsa_next_free_vgpr 216
.amdhsa_next_free_sgpr 100
.amdhsa_accum_offset 216
.amdhsa_group_segment_fixed_size 0
.amdhsa_kernarg_size 72
.amdhsa_user_sgpr_count 2
.amdhsa_user_sgpr_kernarg_segment_ptr 1
.amdhsa_system_sgpr_workgroup_id_x 1
.amdhsa_float_denorm_mode_32 3
.end_amdhsa_kernel
```
